```python
import torch

def _softmax(x, axis=-1):
    return torch.softmax(x, dim=axis)
def _gelu(x):
    return torch.nn.functional.gelu(x, approximate="tanh")
def _silu(x):
    return torch.nn.functional.silu(x)
def _sigmoid(x):
    return torch.sigmoid(x)
def _layernorm(x, axis=-1, eps=1e-5):
    m = x.mean(dim=axis, keepdim=True)
    v = x.var(dim=axis, keepdim=True, unbiased=False)
    return (x - m) / torch.sqrt(v + eps)
def _scatter_add(tgt, idx, src, axis=0):
    return tgt.clone().index_add_(axis, idx, src)
def _segment_sum(src, seg, n):
    out = torch.zeros((n,) + src.shape[1:], dtype=src.dtype)
    return out.index_add_(0, seg, src)
def _pad(x, pw):
    flat = tuple(v for pair in reversed(pw) for v in pair)
    return torch.nn.functional.pad(x, flat)

kernel_name = 'standalone__ssm_conv_s4__prompt'

def setup_inputs():

    _w = (lambda a: (lambda t: t.to(torch.bfloat16) if t.is_floating_point() else t)(torch.as_tensor(a)))
    B, L, D, N = 1, 2048, 1024, 128
    A_re = -(lambda _x: torch.exp(torch.as_tensor(_x)))((lambda *s: torch.randn(*s, dtype=torch.bfloat16) * 3.2)(D, N))
    A_im = torch.pi * (lambda *s: torch.randn(*s, dtype=torch.bfloat16) * 0.05)(D, N)
    B_re = (lambda *s: torch.randn(*s, dtype=torch.bfloat16) * 0.1)(D, N)
    B_im = (lambda *s: torch.randn(*s, dtype=torch.bfloat16) * 0.1)(D, N)
    C_re = (lambda *s: torch.randn(*s, dtype=torch.bfloat16) * 0.1)(D, N)
    C_im = (lambda *s: torch.randn(*s, dtype=torch.bfloat16) * 0.1)(D, N)
    log_dt = (lambda *s: torch.randn(*s, dtype=torch.bfloat16) * 0.05)(D) * 0.5 - 4.0
    Dskip = (lambda *s: torch.randn(*s, dtype=torch.bfloat16) * 0.05)(D)
    return {
        "u": _w((lambda *s: torch.randn(*s, dtype=torch.bfloat16) * 0.05)(B, L, D)),
        "A_re": _w(A_re),
        "A_im": _w(A_im),
        "B_re": _w(B_re),
        "B_im": _w(B_im),
        "C_re": _w(C_re),
        "C_im": _w(C_im),
        "log_dt": _w(log_dt),
        "Dskip": _w(Dskip),
    }

def reference(u, A_re, A_im, B_re, B_im, C_re, C_im, log_dt, Dskip):
    Bsz, L, D = u.shape
    dt = torch.exp(log_dt)[:, None]
    A = A_re + 1j * A_im
    Bc = B_re + 1j * B_im
    Cc = C_re + 1j * C_im
    logdA = dt * A
    dB = dt * Bc
    l = (lambda x, dt: x.to(dt))(torch.arange(L), A_re.dtype)
    P = torch.exp(logdA[:, :, None] * l[None, None, :])
    K = torch.einsum("dn,dnl,dn->dl", Cc, P, dB).real
    L2 = 2 * L
    Kp = _pad(K, ((0, 0), (0, L)))
    up = (lambda x, *d: x.permute(*d))(u, 0, 2, 1)
    up = _pad(up, ((0, 0), (0, 0), (0, L)))
    Kf = (lambda x, axes=(-2,-1): torch.fft.rfft2(x.float(), dim=axes))(Kp[:, None, :], axes=(-2, -1))
    Uf = (lambda x, axes=(-2,-1): torch.fft.rfft2(x.float(), dim=axes))(up[:, :, None, :], axes=(-2, -1))
    Yf = Uf * Kf[None, :, :, :]
    y = (lambda x, s, axes=(-2,-1): torch.fft.irfft2(x, s=s, dim=axes).to(torch.bfloat16))(Yf, (1, L2), axes=(-2, -1))[:, :, 0, :L]
    y = (lambda x, *d: x.permute(*d))(y, 0, 2, 1) + u * Dskip[None, None, :]
    return y
```

```asm
; @launch grid=(256,1,1) block=(512,1,1) lds=137984
.amdgcn_target "amdgcn-amd-amdhsa--gfx950"
.text
.globl standalone__ssm_conv_s4__prompt_kernel
.p2align 12
.fill 832, 4, 0xbf810000
.p2align 8
.type standalone__ssm_conv_s4__prompt_kernel,@function
standalone__ssm_conv_s4__prompt_kernel:
    s_load_dwordx16 s[4:19], s[0:1], 0
    s_load_dwordx4 s[20:23], s[0:1], 64
    s_cmp_ge_u32 s2, 256
    s_cbranch_scc1 Lend
    s_setprio 3
    s_lshr_b32 s29, s2, 3
    v_lshrrev_b32 v42, 6, v0
    s_getpc_b64 s[24:25]
Lpc:
    s_lshl_b32 s3, s29, 9
    v_lshl_add_u32 v41, v42, 6, s3
    v_min_u32 v41, Lend-Lpc-128, v41
    global_load_dword v50, v41, s[24:25] offset:128
    s_and_b32 s28, s2, 7
    v_readfirstlane_b32 s32, v42
    s_lshl_b32 s30, s28, 4
    s_lshr_b32 s28, s29, 1
    s_and_b32 s31, s29, 1
    s_add_u32 s30, s30, s28
    s_lshl_b32 s3, s30, 11
    v_lshl_add_u32 v47, v0, 2, s3
    s_lshl_b32 s30, s30, 4
    s_and_b32 s29, s32, 6
    s_lshl1_add_u32 s29, s29, s30
    v_and_b32 v43, 15, v0
    v_and_b32 v40, 63, v0
    v_and_b32 v45, 48, v0
    s_add_u32 s33, s32, s28
    v_lshrrev_b32 v56, 1, v45
    s_and_b32 s33, s33, 7
    v_sub_u32 v42, v56, v43
    v_lshlrev_b32 v49, 12, v40
    v_cvt_f16_i16 v42, v42
    s_lshl_b32 s34, s33, 18
    s_mov_b32 s35, 0xc980ca00
    s_add_u32 s34, s34, s30
    v_pk_add_f16 v84, v42, s35 op_sel_hi:[0,1]
    s_mov_b32 s42, 0x400000
    v_pk_add_f16 v85, v84, 2.0 op_sel_hi:[1,0]
    s_cmp_eq_u32 s31, 0
    v_pk_add_f16 v86, v85, 2.0 op_sel_hi:[1,0]
    s_cselect_b32 s38, 1835008, s42
    v_pk_add_f16 v87, v86, 2.0 op_sel_hi:[1,0]
    v_pk_add_f16 v88, v87, 2.0 op_sel_hi:[1,0]
    s_min_u32 s47, s38, 0x200000
    v_pk_add_f16 v89, v88, 2.0 op_sel_hi:[1,0]
    s_add_u32 s47, s47, s34
    s_mov_b32 s55, 0x45004500
    s_mov_b32 s39, 0x20000
    s_mov_b32 s56, 0x49004900
    s_mov_b32 s43, 0x20000
    s_mov_b32 s57, 0x4c404c40
    s_and_b32 s24, s32, 1
    v_pk_fma_f16 v8, v84, v84, 2.0 op_sel_hi:[1,1,0] neg_lo:[1,0,0] neg_hi:[1,0,0] clamp
    s_waitcnt lgkmcnt(0)
    global_load_dword v48, v47, s[6:7] nt
    global_load_dword v57, v47, s[8:9] nt
    s_load_dword s64, s[18:19], s29
    s_load_dword s65, s[20:21], s29
    s_mov_b32 s36, s4
    s_mov_b32 s37, s5
    s_mov_b32 s40, s22
    s_mov_b32 s41, s23
    s_lshl_b32 s24, s24, 4
    v_pk_fma_f16 v12, v86, v86, s55 neg_lo:[1,0,0] neg_hi:[1,0,0] clamp
    s_mul_i32 s51, s32, 7200
    v_pk_fma_f16 v16, v86, v86, s56 neg_lo:[1,0,0] neg_hi:[1,0,0] clamp
    s_mul_i32 s59, s32, 4608
    v_pk_fma_f16 v20, v86, v86, s57 neg_lo:[1,0,0] neg_hi:[1,0,0] clamp
    s_add_u32 s52, s59, 33264
    v_pk_fma_f16 v9, v85, v85, 2.0 op_sel_hi:[1,1,0] neg_lo:[1,0,0] neg_hi:[1,0,0] clamp
    s_add_u32 s60, s59, 94464
    v_pk_fma_f16 v13, v87, v87, s55 neg_lo:[1,0,0] neg_hi:[1,0,0] clamp
    v_pk_fma_f16 v17, v87, v87, s56 neg_lo:[1,0,0] neg_hi:[1,0,0] clamp
    s_add_u32 s59, s59, 57600
    v_pk_fma_f16 v21, v87, v87, s57 neg_lo:[1,0,0] neg_hi:[1,0,0] clamp
    s_lshl_b32 s50, s33, 8
    v_pk_fma_f16 v10, v86, v86, 2.0 op_sel_hi:[1,1,0] neg_lo:[1,0,0] neg_hi:[1,0,0] clamp
    s_barrier
    global_load_dword v64, v47, s[10:11] nt
    global_load_dword v65, v47, s[12:13] nt
    global_load_dword v66, v47, s[14:15] nt
    global_load_dword v67, v47, s[16:17] nt
    s_add_u32 s50, s50, 32768
    v_pk_fma_f16 v14, v88, v88, s55 neg_lo:[1,0,0] neg_hi:[1,0,0] clamp
    s_mov_b32 m0, s51
    v_pk_fma_f16 v18, v88, v88, s56 neg_lo:[1,0,0] neg_hi:[1,0,0] clamp
    s_movk_i32 s61, 288
    v_pk_fma_f16 v22, v88, v88, s57 neg_lo:[1,0,0] neg_hi:[1,0,0] clamp
    s_mul_i32 s49, s32, 832
    v_pk_fma_f16 v11, v87, v87, 2.0 op_sel_hi:[1,1,0] neg_lo:[1,0,0] neg_hi:[1,0,0] clamp
    s_add_u32 s49, s49, 131328
    v_pk_fma_f16 v15, v89, v89, s55 neg_lo:[1,0,0] neg_hi:[1,0,0] clamp
    s_add_u32 s3, s60, 16
    v_pk_fma_f16 v19, v89, v89, s56 neg_lo:[1,0,0] neg_hi:[1,0,0] clamp
    v_lshrrev_b32 v44, 4, v40
    v_pk_fma_f16 v23, v89, v89, s57 neg_lo:[1,0,0] neg_hi:[1,0,0] clamp
    v_lshlrev_b32 v46, 2, v43
    s_barrier
    buffer_load_dwordx4 v[68:71], v49, s[36:39], s34 offen offset:0 nt
    buffer_load_dwordx4 v[72:75], v49, s[36:39], s34 offen offset:2048 nt
    s_setprio 3
    v_mov_b32 v51, 0x3c00
    v_mov_b64 v[60:61], 0
    v_mov_b64 v[62:63], 0
    v_lshl_add_u32 v41, v40, 3, s59
    v_add_u32 v31, s51, v45
    v_mad_u32_u24 v42, v43, s61, v45
    v_add_u32 v28, s60, v42
    ds_write_b64 v41, v[60:61]
    ds_write_addtid_b32 v51 offset:0
    v_lshl_add_u32 v41, v40, 2, s49
    ds_write_b32 v41, v60
    s_mov_b32 s62, 0xba893210
    s_mov_b32 s63, 0xc5fff644
    v_lshrrev_b64 v[58:59], v46, s[62:63]
    v_and_b32 v58, 15, v58
    v_mad_u32_u24 v29, v58, s61, v31
    s_mov_b32 s62, 0xa98745f0
    s_mov_b32 s63, 0x45e3dcb6
    v_lshrrev_b64 v[58:59], v46, s[62:63]
    v_and_b32 v58, 15, v58
    s_setprio 2
    v_mad_u32_u24 v30, v58, s61, v31
    s_mov_b32 s44, 0x05040100
    s_mov_b32 s45, 0x07060302
    s_mov_b32 s58, 0xffff0000
    s_mov_b32 s66, s58
    s_mov_b32 s67, 0xffff
    v_min_u32 v42, 39, v40
    v_lshrrev_b32 v58, 3, v42
    v_lshl_add_u32 v42, v42, 3, s60
    v_lshl_add_u32 v39, v58, 10, v42
    s_mov_b32 s62, 0xf800f800
    s_mov_b32 s63, s62
    v_sub_u32 v42, 31, v43
    v_mov_b32 v58, 543
    v_cndmask_b32 v42, v42, v58, s[62:63]
    v_lshl_add_u32 v42, v42, 1, s3
    s_movk_i32 s35, 1086
    v_mad_u32_u24 v37, v44, s35, v42
    s_mov_b32 s35, 0xffd5502a
    v_lshlrev_b32 v42, 1, v43
    s_setprio 1
    v_bfe_u32 v42, s35, v42, 2
    v_mul_u32_u24 v42, 0x202, v42
    v_add_u32 v38, 0x100, v42
    v_and_b32 v52, 3, v0
    v_mul_u32_u24 v42, 1086, v52
    v_lshl_add_u32 v42, v43, 1, v42
    v_sub_u32 v42, v45, v42
    s_add_u32 s35, s3, 3288
    v_add_u32 v2, s35, v42
    v_lshl_add_u32 v42, v45, 1, v43
    s_add_u32 s35, s49, 320
    v_lshl_add_u32 v35, v42, 2, s35
    v_lshl_add_u32 v36, v42, 1, s49
    v_sub_u32 v42, v46, v45
    v_lshl_add_u32 v3, v42, 1, s35
    s_setprio 0
    s_add_u32 s35, s49, 48
    v_add_u32 v4, s35, v42
    v_lshl_add_u32 v42, v43, 5, v45
    v_add_u32 v1, s59, v42
    v_and_b32 v55, 8, v56
    v_lshl_add_u32 v42, v43, 4, v55
    v_and_b32 v53, 32, v0
    v_lshl_add_u32 v42, v53, 4, v42
    s_add_u32 s35, s3, 816
    v_sub_u32 v32, s35, v42
    v_add_u32 v33, 1088, v32
    v_add_u32 v34, 2176, v32
    s_mov_b32 s53, 0x8a978b98
    v_mov_b32 v59, 0x0c0c0c0c
    v_pk_add_f16 v42, v84, -1.0 op_sel_hi:[1,0]
    v_pk_fma_f16 v42, v84, v42, 1.0 op_sel_hi:[1,1,0] neg_lo:[1,0,0] neg_hi:[1,0,0] clamp
    v_pk_fma_f16 v42, v42, s53, v59 op_sel_hi:[1,0,1]
    v_pk_fma_f16 v24, v16, s53, v42 op_sel:[0,1,0]
    v_pk_add_f16 v42, v85, -1.0 op_sel_hi:[1,0]
    v_pk_fma_f16 v42, v85, v42, 1.0 op_sel_hi:[1,1,0] neg_lo:[1,0,0] neg_hi:[1,0,0] clamp
    v_pk_fma_f16 v42, v42, s53, v59 op_sel_hi:[1,0,1]
    v_pk_fma_f16 v25, v17, s53, v42 op_sel:[0,1,0]
    v_pk_add_f16 v42, v86, -1.0 op_sel_hi:[1,0]
    v_pk_fma_f16 v42, v86, v42, 1.0 op_sel_hi:[1,1,0] neg_lo:[1,0,0] neg_hi:[1,0,0] clamp
    v_pk_fma_f16 v42, v42, s53, v59 op_sel_hi:[1,0,1]
    v_pk_fma_f16 v26, v18, s53, v42 op_sel:[0,1,0]
    v_pk_add_f16 v42, v87, -1.0 op_sel_hi:[1,0]
    v_pk_fma_f16 v42, v87, v42, 1.0 op_sel_hi:[1,1,0] neg_lo:[1,0,0] neg_hi:[1,0,0] clamp
    v_mov_b32 v92, 0x3fb8aa3b
    s_waitcnt lgkmcnt(0)
    s_lshr_b32 s64, s64, s24
    s_lshl_b32 s64, s64, 16
    v_mul_f32 v90, s64, v92
    v_exp_f32 v90, v90
    s_lshr_b32 s65, s65, s24
    v_cvt_pk_bf16_f32 v90, v90, v90
    s_lshl_b32 s65, s65, 16
    v_and_b32 v90, s58, v90
    v_mul_f32 v92, v92, v90
    v_mul_f32 v93, 0.15915494, v90
    v_writelane_b32 v62, s65, 0
    s_setprio 3
    s_cmp_eq_u32 s31, 0
    s_cbranch_scc1 LtypeA
    s_waitcnt vmcnt(6)
    v_lshlrev_b32 v95, 16, v57
    v_lshlrev_b32 v94, 16, v48
    v_mul_f32 v95, v95, v93
    v_fract_f32 v89, v95
    v_cos_f32 v50, v89
    v_sin_f32 v51, v89
    v_mul_f32 v94, v94, v92
    v_exp_f32 v88, v94
    s_nop 0
    v_pk_mul_f32 v[50:51], v[50:51], v[88:89] op_sel_hi:[1,0]
    v_pk_mul_f32 v[46:47], v[50:51], v[50:51] op_sel_hi:[1,0]
    v_cvt_pk_f16_f32 v63, v50, v51
    ds_write_addtid_b32 v63 offset:288
    v_pk_fma_f32 v[46:47], v[50:51], v[50:51], v[46:47] op_sel:[1,1,0] op_sel_hi:[0,1,1] neg_lo:[0,1,0]
    v_pk_mul_f32 v[254:255], v[46:47], v[46:47] op_sel_hi:[1,0]
    v_cvt_pk_f16_f32 v253, v46, v47
    ds_write_addtid_b32 v253 offset:576
    v_pk_mul_f16 v252, v253, v63 op_sel_hi:[1,0]
    v_pk_fma_f16 v252, v253, v63, v252 op_sel:[1,1,0] op_sel_hi:[0,1,1] neg_lo:[0,1,0]
    v_pk_fma_f32 v[254:255], v[46:47], v[46:47], v[254:255] op_sel:[1,1,0] op_sel_hi:[0,1,1] neg_lo:[0,1,0]
    ds_write_addtid_b32 v252 offset:864
    v_pk_mul_f32 v[94:95], v[254:255], v[254:255] op_sel_hi:[1,0]
    v_cvt_pk_f16_f32 v89, v254, v255
    v_pk_mul_f16 v88, v89, v63 op_sel_hi:[1,0]
    ds_write_addtid_b32 v89 offset:2592
    v_pk_fma_f16 v88, v89, v63, v88 op_sel:[1,1,0] op_sel_hi:[0,1,1] neg_lo:[0,1,0]
    v_pk_fma_f32 v[94:95], v[254:255], v[254:255], v[94:95] op_sel:[1,1,0] op_sel_hi:[0,1,1] neg_lo:[0,1,0]
    v_pk_mul_f32 v[50:51], v[94:95], v[94:95] op_sel_hi:[1,0]
    ds_write_addtid_b32 v88 offset:2304
    v_pk_mul_f16 v252, v89, v253 op_sel_hi:[1,0]
    v_pk_fma_f16 v252, v89, v253, v252 op_sel:[1,1,0] op_sel_hi:[0,1,1] neg_lo:[0,1,0]
    v_cvt_pk_f16_f32 v56, v94, v95
    ds_write_addtid_b32 v252 offset:2880
    v_pk_fma_f32 v[50:51], v[94:95], v[94:95], v[50:51] op_sel:[1,1,0] op_sel_hi:[0,1,1] neg_lo:[0,1,0]
    v_pk_mul_f32 v[254:255], v[50:51], v[50:51] op_sel_hi:[1,0]
    v_pk_mul_f16 v88, v252, v63 op_sel_hi:[1,0]
    ds_write_addtid_b32 v56 offset:4608
    v_pk_fma_f16 v88, v252, v63, v88 op_sel:[1,1,0] op_sel_hi:[0,1,1] neg_lo:[0,1,0]
    v_pk_fma_f32 v[254:255], v[50:51], v[50:51], v[254:255] op_sel:[1,1,0] op_sel_hi:[0,1,1] neg_lo:[0,1,0]
    v_pk_mul_f32 v[46:47], v[254:255], v[254:255] op_sel_hi:[1,0]
    ds_write_addtid_b32 v88 offset:3168
    v_cvt_pk_f16_f32 v95, v254, v255
    v_pk_fma_f32 v[46:47], v[254:255], v[254:255], v[46:47] op_sel:[1,1,0] op_sel_hi:[0,1,1] neg_lo:[0,1,0]
    v_pk_mul_f32 v[250:251], v[46:47], v[46:47] op_sel_hi:[1,0]
    s_setprio 2
    v_pk_fma_f32 v[250:251], v[46:47], v[46:47], v[250:251] op_sel:[1,1,0] op_sel_hi:[0,1,1] neg_lo:[0,1,0]
    v_pk_mul_f32 v[248:249], v[250:251], v[250:251] op_sel_hi:[1,0]
    v_cvt_pk_f16_f32 v94, v250, v251
    ds_write_addtid_b32 v94 offset:2016
    v_pk_fma_f32 v[248:249], v[250:251], v[250:251], v[248:249] op_sel:[1,1,0] op_sel_hi:[0,1,1] neg_lo:[0,1,0]
    v_pk_mul_f32 v[254:255], v[248:249], v[248:249] op_sel_hi:[1,0]
    v_cvt_pk_f16_f32 v88, v248, v249
    ds_read_b128 v[84:87], v31 offset:2016
    v_pk_mul_f16 v63, v56, v88 op_sel_hi:[1,0]
    v_pk_fma_f16 v63, v56, v88, v63 op_sel:[1,1,0] op_sel_hi:[0,1,1] neg_lo:[0,1,0]
    v_pk_mul_f16 v94, v89, v88 op_sel_hi:[1,0]
    ds_write_addtid_b32 v63 offset:3456
    v_pk_fma_f16 v94, v89, v88, v94 op_sel:[1,1,0] op_sel_hi:[0,1,1] neg_lo:[0,1,0]
    v_pk_fma_f32 v[254:255], v[248:249], v[248:249], v[254:255] op_sel:[1,1,0] op_sel_hi:[0,1,1] neg_lo:[0,1,0]
    v_cvt_pk_f16_f32 v54, v254, v255
    ds_read_b128 v[96:99], v31 offset:2080
    v_pk_mul_f16 v51, v63, v56 op_sel_hi:[1,0]
    v_pk_fma_f16 v51, v63, v56, v51 op_sel:[1,1,0] op_sel_hi:[0,1,1] neg_lo:[0,1,0]
    v_pk_mul_f16 v50, v94, v56 op_sel_hi:[1,0]
    ds_write_addtid_b32 v94 offset:4320
    v_pk_fma_f16 v50, v94, v56, v50 op_sel:[1,1,0] op_sel_hi:[0,1,1] neg_lo:[0,1,0]
    v_and_b32 v255, s58, v57
    v_and_b32 v254, s58, v48
    ds_read_b128 v[100:103], v31 offset:2144
    v_mul_f32 v255, v255, v93
    v_mul_f32 v254, v254, v92
    v_pk_mul_f16 v89, v51, v88 op_sel_hi:[1,0]
    ds_write_addtid_b32 v51 offset:3744
    v_pk_fma_f16 v89, v51, v88, v89 op_sel:[1,1,0] op_sel_hi:[0,1,1] neg_lo:[0,1,0]
    v_fract_f32 v47, v255
    v_pk_mul_f16 v94, v51, v54 op_sel_hi:[1,0]
    ds_read_b128 v[104:107], v31 offset:2208
    v_exp_f32 v46, v254
    v_pk_fma_f16 v94, v51, v54, v94 op_sel:[1,1,0] op_sel_hi:[0,1,1] neg_lo:[0,1,0]
    ds_write_addtid_b32 v50 offset:4032
    v_cos_f32 v92, v47
    v_pk_mul_f16 v63, v50, v88 op_sel_hi:[1,0]
    ds_write_addtid_b32 v89 offset:5472
    v_pk_fma_f16 v63, v50, v88, v63 op_sel:[1,1,0] op_sel_hi:[0,1,1] neg_lo:[0,1,0]
    v_sin_f32 v93, v47
    ds_write_addtid_b32 v94 offset:6336
    v_pk_mul_f16 v255, v89, v54 op_sel_hi:[1,0]
    v_pk_fma_f16 v255, v89, v54, v255 op_sel:[1,1,0] op_sel_hi:[0,1,1] neg_lo:[0,1,0]
    v_pk_mul_f32 v[92:93], v[92:93], v[46:47] op_sel_hi:[1,0]
    ds_write_addtid_b32 v63 offset:5184
    v_pk_mul_f16 v254, v50, v54 op_sel_hi:[1,0]
    v_pk_fma_f16 v254, v50, v54, v254 op_sel:[1,1,0] op_sel_hi:[0,1,1] neg_lo:[0,1,0]
    v_pk_mul_f32 v[250:251], v[92:93], v[92:93] op_sel_hi:[1,0]
    ds_write_addtid_b32 v255 offset:6912
    v_pk_mul_f16 v249, v94, v54 op_sel_hi:[1,0]
    v_pk_fma_f16 v249, v94, v54, v249 op_sel:[1,1,0] op_sel_hi:[0,1,1] neg_lo:[0,1,0]
    v_cvt_pk_f16_f32 v248, v92, v93
    s_waitcnt vmcnt(2)
    ds_write_addtid_b32 v254 offset:6048
    v_pk_mul_f16 v89, v255, v54 op_sel_hi:[1,0]
    v_pk_fma_f16 v89, v255, v54, v89 op_sel:[1,1,0] op_sel_hi:[0,1,1] neg_lo:[0,1,0]
    v_lshlrev_b32 v51, 16, v67
    ds_write_addtid_b32 v249 offset:4896
    v_lshlrev_b32 v50, 16, v66
    v_pk_mul_f16 v94, v249, v54 op_sel_hi:[1,0]
    v_pk_fma_f16 v94, v249, v54, v94 op_sel:[1,1,0] op_sel_hi:[0,1,1] neg_lo:[0,1,0]
    ds_write_addtid_b32 v89 offset:5760
    v_lshlrev_b32 v254, 16, v64
    v_lshlrev_b32 v255, 16, v65
    v_pk_mul_f16 v63, v253, v88 op_sel_hi:[1,0]
    ds_write_addtid_b32 v94 offset:6624
    v_pk_mul_f32 v[46:47], v[254:255], v[50:51] op_sel_hi:[1,0]
    v_pk_fma_f32 v[46:47], v[254:255], v[50:51], v[46:47] op_sel:[1,1,0] op_sel_hi:[0,1,1] neg_lo:[0,1,0]
    v_pk_fma_f32 v[250:251], v[92:93], v[92:93], v[250:251] op_sel:[1,1,0] op_sel_hi:[0,1,1] neg_lo:[0,1,0]
    ds_read_b128 v[108:111], v30 offset:2592
    v_pk_mul_f32 v[246:247], v[250:251], v[250:251] op_sel_hi:[1,0]
    v_cvt_pk_f16_f32 v249, v250, v251
    v_pk_fma_f32 v[246:247], v[250:251], v[250:251], v[246:247] op_sel:[1,1,0] op_sel_hi:[0,1,1] neg_lo:[0,1,0]
    ds_write_addtid_b32 v88 offset:1152
    v_pk_mul_f32 v[254:255], v[246:247], v[246:247] op_sel_hi:[1,0]
    v_cvt_pk_f16_f32 v245, v246, v247
    v_pk_fma_f32 v[254:255], v[246:247], v[246:247], v[254:255] op_sel:[1,1,0] op_sel_hi:[0,1,1] neg_lo:[0,1,0]
    ds_read_b128 v[112:115], v30 offset:2656
    v_pk_fma_f16 v63, v253, v88, v63 op_sel:[1,1,0] op_sel_hi:[0,1,1] neg_lo:[0,1,0]
    v_and_b32 v251, s58, v67
    v_and_b32 v250, s58, v66
    ds_write_addtid_b32 v63 offset:1728
    v_and_b32 v92, s58, v64
    v_and_b32 v93, s58, v65
    v_pk_mul_f32 v[246:247], v[92:93], v[250:251] op_sel_hi:[1,0]
    ds_read_b128 v[116:119], v30 offset:2720
    v_pk_mul_f16 v253, v252, v88 op_sel_hi:[1,0]
    v_pk_fma_f16 v253, v252, v88, v253 op_sel:[1,1,0] op_sel_hi:[0,1,1] neg_lo:[0,1,0]
    v_pk_fma_f32 v[246:247], v[92:93], v[250:251], v[246:247] op_sel:[1,1,0] op_sel_hi:[0,1,1] neg_lo:[0,1,0]
    ds_write_addtid_b32 v253 offset:1440
    v_max3_f32 v244, abs(v46), abs(v47), abs(v246)
    v_max_f32_e64 v244, v244, abs(v247)
    v_pk_mul_f32 v[50:51], v[254:255], v[254:255] op_sel_hi:[1,0]
    ds_read_b128 v[64:67], v30 offset:2784
    v_max_u32_dpp v244, v244, v244 row_shr:1 row_mask:0xf bank_mask:0xf
    v_cvt_pk_f16_f32 v252, v254, v255
    v_pk_fma_f32 v[50:51], v[254:255], v[254:255], v[50:51] op_sel:[1,1,0] op_sel_hi:[0,1,1] neg_lo:[0,1,0]
    ds_read_b128 v[120:123], v29 offset:0
    v_max_u32_dpp v244, v244, v244 row_shr:2 row_mask:0xf bank_mask:0xf
    v_pk_mul_f32 v[250:251], v[50:51], v[50:51] op_sel_hi:[1,0]
    v_pk_fma_f32 v[250:251], v[50:51], v[50:51], v[250:251] op_sel:[1,1,0] op_sel_hi:[0,1,1] neg_lo:[0,1,0]
    ds_read_b128 v[124:127], v29 offset:64
    v_max_u32_dpp v244, v244, v244 row_shr:4 row_mask:0xf bank_mask:0xf
    v_pk_mul_f32 v[254:255], v[250:251], v[250:251] op_sel_hi:[1,0]
    v_cvt_pk_f16_f32 v253, v250, v251
    ds_read_b128 v[128:131], v29 offset:128
    v_max_u32_dpp v244, v244, v244 row_shr:8 row_mask:0xf bank_mask:0xf
    v_pk_fma_f32 v[254:255], v[250:251], v[250:251], v[254:255] op_sel:[1,1,0] op_sel_hi:[0,1,1] neg_lo:[0,1,0]
    v_pk_mul_f32 v[92:93], v[254:255], v[254:255] op_sel_hi:[1,0]
    ds_read_b128 v[132:135], v29 offset:192
    v_max_u32_dpp v244, v244, v244 row_bcast:15 row_mask:0xa bank_mask:0xf
    v_pk_fma_f32 v[92:93], v[254:255], v[254:255], v[92:93] op_sel:[1,1,0] op_sel_hi:[0,1,1] neg_lo:[0,1,0]
    v_pk_mul_f32 v[88:89], v[92:93], v[92:93] op_sel_hi:[1,0]
    s_mov_b32 m0, s52
    v_max_u32_dpp v244, v244, v244 row_bcast:31 row_mask:0xc bank_mask:0xf
    v_cvt_pk_f16_f32 v251, v92, v93
    v_readlane_b32 s46, v244, 63
    s_nop 0
    s_and_b32 s46, s46, 0x7f800000
    s_sub_u32 s48, 0x7f000000, s46
    v_pk_mul_f32 v[46:47], v[46:47], s[48:49] op_sel_hi:[1,0]
    v_pk_mul_f32 v[246:247], v[246:247], s[48:49] op_sel_hi:[1,0]
    v_cvt_pk_f16_f32 v255, v46, -v47
    ds_write_addtid_b32 v255 offset:61200
    v_pk_mul_f16 v254, v255, v56 op_sel_hi:[1,0]
    v_pk_fma_f16 v254, v255, v56, v254 op_sel:[1,1,0] op_sel_hi:[0,1,1] neg_hi:[0,1,0]
    v_pk_mul_f16 v250, v255, v95 op_sel_hi:[1,0]
    ds_write_addtid_b32 v254 offset:61488
    v_pk_fma_f16 v250, v255, v95, v250 op_sel:[1,1,0] op_sel_hi:[0,1,1] neg_hi:[0,1,0]
    v_pk_mul_f16 v244, v254, v56 op_sel_hi:[1,0]
    v_pk_fma_f16 v244, v254, v56, v244 op_sel:[1,1,0] op_sel_hi:[0,1,1] neg_hi:[0,1,0]
    ds_write_addtid_b32 v250 offset:62352
    v_pk_mul_f16 v94, v254, v95 op_sel_hi:[1,0]
    v_pk_fma_f16 v94, v254, v95, v94 op_sel:[1,1,0] op_sel_hi:[0,1,1] neg_hi:[0,1,0]
    v_cvt_pk_f16_f32 v63, v246, -v247
    ds_write_addtid_b32 v244 offset:61776
    v_pk_mul_f16 v255, v250, v95 op_sel_hi:[1,0]
    v_pk_fma_f16 v255, v250, v95, v255 op_sel:[1,1,0] op_sel_hi:[0,1,1] neg_hi:[0,1,0]
    v_pk_mul_f16 v57, v244, v56 op_sel_hi:[1,0]
    ds_write_addtid_b32 v94 offset:62640
    v_pk_fma_f16 v57, v244, v56, v57 op_sel:[1,1,0] op_sel_hi:[0,1,1] neg_hi:[0,1,0]
    v_pk_mul_f16 v254, v244, v95 op_sel_hi:[1,0]
    v_pk_fma_f16 v254, v244, v95, v254 op_sel:[1,1,0] op_sel_hi:[0,1,1] neg_hi:[0,1,0]
    ds_write_addtid_b32 v255 offset:63504
    v_pk_mul_f16 v250, v94, v95 op_sel_hi:[1,0]
    v_pk_fma_f16 v250, v94, v95, v250 op_sel:[1,1,0] op_sel_hi:[0,1,1] neg_hi:[0,1,0]
    v_pk_fma_f32 v[88:89], v[92:93], v[92:93], v[88:89] op_sel:[1,1,0] op_sel_hi:[0,1,1] neg_lo:[0,1,0]
    ds_write_addtid_b32 v57 offset:62064
    v_pk_mul_f16 v247, v255, v95 op_sel_hi:[1,0]
    v_pk_fma_f16 v247, v255, v95, v247 op_sel:[1,1,0] op_sel_hi:[0,1,1] neg_hi:[0,1,0]
    v_pk_mul_f32 v[50:51], v[88:89], v[88:89] op_sel_hi:[1,0]
    ds_write_addtid_b32 v254 offset:62928
    v_pk_mul_f16 v246, v57, v95 op_sel_hi:[1,0]
    v_pk_fma_f16 v246, v57, v95, v246 op_sel:[1,1,0] op_sel_hi:[0,1,1] neg_hi:[0,1,0]
    v_cvt_pk_f16_f32 v244, v88, v89
    ds_write_addtid_b32 v250 offset:63792
    v_pk_mul_f16 v255, v254, v95 op_sel_hi:[1,0]
    v_pk_fma_f16 v255, v254, v95, v255 op_sel:[1,1,0] op_sel_hi:[0,1,1] neg_hi:[0,1,0]
    v_pk_fma_f32 v[50:51], v[88:89], v[88:89], v[50:51] op_sel:[1,1,0] op_sel_hi:[0,1,1] neg_lo:[0,1,0]
    ds_write_addtid_b32 v247 offset:64656
    v_pk_mul_f16 v94, v250, v95 op_sel_hi:[1,0]
    v_pk_fma_f16 v94, v250, v95, v94 op_sel:[1,1,0] op_sel_hi:[0,1,1] neg_hi:[0,1,0]
    v_cvt_pk_f16_f32 v93, v50, v51
    ds_write_addtid_b32 v246 offset:63216
    v_pk_mul_f16 v254, v246, v95 op_sel_hi:[1,0]
    v_pk_fma_f16 v254, v246, v95, v254 op_sel:[1,1,0] op_sel_hi:[0,1,1] neg_hi:[0,1,0]
    v_mul_f32 v90, s46, v90
    ds_write_addtid_b32 v255 offset:64080
    v_pk_mul_f16 v250, v255, v95 op_sel_hi:[1,0]
    v_pk_fma_f16 v250, v255, v95, v250 op_sel:[1,1,0] op_sel_hi:[0,1,1] neg_hi:[0,1,0]
    v_mul_f32 v91, 0x43000000, v90
    ds_write_addtid_b32 v94 offset:64944
    v_pk_mul_f16 v247, v254, v95 op_sel_hi:[1,0]
    v_pk_fma_f16 v247, v254, v95, v247 op_sel:[1,1,0] op_sel_hi:[0,1,1] neg_hi:[0,1,0]
    v_cndmask_b32 v88, 0, v91, s[66:67]
    ds_write_addtid_b32 v254 offset:64368
    v_pk_mul_f16 v255, v63, v252 op_sel_hi:[1,0]
    v_pk_fma_f16 v255, v63, v252, v255 op_sel:[1,1,0] op_sel_hi:[0,1,1] neg_hi:[0,1,0]
    v_pk_mul_f16 v246, v63, v253 op_sel_hi:[1,0]
    ds_write_addtid_b32 v250 offset:65232
    v_pk_fma_f16 v246, v63, v253, v246 op_sel:[1,1,0] op_sel_hi:[0,1,1] neg_hi:[0,1,0]
    v_pk_mul_f16 v95, v255, v252 op_sel_hi:[1,0]
    v_pk_fma_f16 v95, v255, v252, v95 op_sel:[1,1,0] op_sel_hi:[0,1,1] neg_hi:[0,1,0]
    ds_write_addtid_b32 v247 offset:65520
    v_pk_mul_f16 v254, v255, v253 op_sel_hi:[1,0]
    v_pk_fma_f16 v254, v255, v253, v254 op_sel:[1,1,0] op_sel_hi:[0,1,1] neg_hi:[0,1,0]
    v_pk_mul_f16 v250, v246, v253 op_sel_hi:[1,0]
    s_mov_b32 m0, s52
    ds_read_b128 v[136:139], v28 offset:0
    v_pk_fma_f16 v250, v246, v253, v250 op_sel:[1,1,0] op_sel_hi:[0,1,1] neg_hi:[0,1,0]
    v_pk_mul_f16 v247, v95, v252 op_sel_hi:[1,0]
    v_pk_fma_f16 v247, v95, v252, v247 op_sel:[1,1,0] op_sel_hi:[0,1,1] neg_hi:[0,1,0]
    ds_read_b128 v[140:143], v28 offset:64
    v_pk_mul_f16 v94, v95, v253 op_sel_hi:[1,0]
    v_pk_fma_f16 v94, v95, v253, v94 op_sel:[1,1,0] op_sel_hi:[0,1,1] neg_hi:[0,1,0]
    v_pk_mul_f16 v92, v254, v253 op_sel_hi:[1,0]
    ds_read_b128 v[144:147], v28 offset:128
    v_pk_fma_f16 v92, v254, v253, v92 op_sel:[1,1,0] op_sel_hi:[0,1,1] neg_hi:[0,1,0]
    v_pk_mul_f16 v57, v250, v253 op_sel_hi:[1,0]
    v_pk_fma_f16 v57, v250, v253, v57 op_sel:[1,1,0] op_sel_hi:[0,1,1] neg_hi:[0,1,0]
    s_waitcnt lgkmcnt(2)
    ds_read_b128 v[148:151], v28 offset:192
    v_mfma_f32_16x16x32_f16 v[152:155], v[108:111], v[136:139], 0
    v_pk_mul_f16 v56, v136, v84 op_sel_hi:[1,0]
    ds_write_addtid_b32 v63 offset:61200
    v_pk_mul_f16 v54, v137, v85 op_sel_hi:[1,0]
    v_pk_fma_f16 v84, v136, v84, v56 op_sel:[1,1,0] op_sel_hi:[0,1,1] neg_hi:[0,1,0]
    v_pk_fma_f16 v85, v137, v85, v54 op_sel:[1,1,0] op_sel_hi:[0,1,1] neg_hi:[0,1,0]
    s_waitcnt lgkmcnt(2)
    ds_write_addtid_b32 v255 offset:61488
    v_mfma_f32_16x16x32_f16 v[152:155], v[112:115], v[140:143], v[152:155]
    v_pk_mul_f16 v51, v138, v86 op_sel_hi:[1,0]
    ds_write_addtid_b32 v246 offset:62352
    v_pk_mul_f16 v63, v139, v87 op_sel_hi:[1,0]
    v_pk_fma_f16 v86, v138, v86, v51 op_sel:[1,1,0] op_sel_hi:[0,1,1] neg_hi:[0,1,0]
    v_pk_fma_f16 v87, v139, v87, v63 op_sel:[1,1,0] op_sel_hi:[0,1,1] neg_hi:[0,1,0]
    ds_write_addtid_b32 v95 offset:61776
    v_pk_mul_f16 v255, v140, v96 op_sel_hi:[1,0]
    v_pk_mul_f16 v56, v141, v97 op_sel_hi:[1,0]
    v_pk_fma_f16 v96, v140, v96, v255 op_sel:[1,1,0] op_sel_hi:[0,1,1] neg_hi:[0,1,0]
    ds_write_addtid_b32 v254 offset:62640
    v_mfma_f32_16x16x32_f16 v[156:159], v[108:111], v[84:87], 0
    v_pk_fma_f16 v97, v141, v97, v56 op_sel:[1,1,0] op_sel_hi:[0,1,1] neg_hi:[0,1,0]
    ds_write_addtid_b32 v250 offset:63504
    v_pk_mul_f16 v246, v142, v98 op_sel_hi:[1,0]
    v_pk_mul_f16 v95, v143, v99 op_sel_hi:[1,0]
    v_pk_fma_f16 v98, v142, v98, v246 op_sel:[1,1,0] op_sel_hi:[0,1,1] neg_hi:[0,1,0]
    ds_write_addtid_b32 v247 offset:62064
    v_mfma_f32_16x16x32_f16 v[152:155], v[116:119], v[144:147], v[152:155]
    v_pk_fma_f16 v99, v143, v99, v95 op_sel:[1,1,0] op_sel_hi:[0,1,1] neg_hi:[0,1,0]
    ds_write_addtid_b32 v94 offset:62928
    v_pk_mul_f16 v255, v247, v253 op_sel_hi:[1,0]
    v_pk_fma_f16 v255, v247, v253, v255 op_sel:[1,1,0] op_sel_hi:[0,1,1] neg_hi:[0,1,0]
    v_pk_mul_f16 v254, v144, v100 op_sel_hi:[1,0]
    ds_write_addtid_b32 v92 offset:63792
    v_mfma_f32_16x16x32_f16 v[156:159], v[112:115], v[96:99], v[156:159]
    v_pk_mul_f16 v250, v94, v253 op_sel_hi:[1,0]
    ds_write_addtid_b32 v57 offset:64656
    v_pk_fma_f16 v250, v94, v253, v250 op_sel:[1,1,0] op_sel_hi:[0,1,1] neg_hi:[0,1,0]
    v_pk_mul_f16 v247, v92, v253 op_sel_hi:[1,0]
    v_pk_fma_f16 v247, v92, v253, v247 op_sel:[1,1,0] op_sel_hi:[0,1,1] neg_hi:[0,1,0]
    ds_write_addtid_b32 v255 offset:63216
    v_pk_mul_f16 v246, v255, v253 op_sel_hi:[1,0]
    v_pk_fma_f16 v246, v255, v253, v246 op_sel:[1,1,0] op_sel_hi:[0,1,1] neg_hi:[0,1,0]
    v_pk_mul_f16 v95, v145, v101 op_sel_hi:[1,0]
    ds_write_addtid_b32 v250 offset:64080
    v_pk_mul_f16 v94, v250, v253 op_sel_hi:[1,0]
    v_pk_fma_f16 v94, v250, v253, v94 op_sel:[1,1,0] op_sel_hi:[0,1,1] neg_hi:[0,1,0]
    v_pk_fma_f16 v100, v144, v100, v254 op_sel:[1,1,0] op_sel_hi:[0,1,1] neg_hi:[0,1,0]
    s_waitcnt lgkmcnt(2)
    ds_write_addtid_b32 v247 offset:64944
    v_mfma_f32_16x16x32_f16 v[152:155], v[64:67], v[148:151], v[152:155]
    v_pk_mul_f16 v255, v246, v253 op_sel_hi:[1,0]
    ds_write_addtid_b32 v246 offset:64368
    v_pk_fma_f16 v255, v246, v253, v255 op_sel:[1,1,0] op_sel_hi:[0,1,1] neg_hi:[0,1,0]
    v_pk_fma_f16 v101, v145, v101, v95 op_sel:[1,1,0] op_sel_hi:[0,1,1] neg_hi:[0,1,0]
    v_pk_mul_f16 v254, v146, v102 op_sel_hi:[1,0]
    ds_write_addtid_b32 v94 offset:65232
    v_pk_mul_f16 v250, v252, v244 op_sel_hi:[1,0]
    v_pk_fma_f16 v250, v252, v244, v250 op_sel:[1,1,0] op_sel_hi:[0,1,1] neg_lo:[0,1,0]
    v_pk_mul_f16 v247, v245, v244 op_sel_hi:[1,0]
    ds_write_addtid_b32 v255 offset:65520
    v_mfma_f32_16x16x32_f16 v[108:111], v[120:123], v[136:139], 0
    v_pk_mul_f16 v253, v147, v103 op_sel_hi:[1,0]
    ds_read_b128 v[112:115], v28 offset:0
    v_pk_fma_f16 v102, v146, v102, v254 op_sel:[1,1,0] op_sel_hi:[0,1,1] neg_hi:[0,1,0]
    v_pk_fma_f16 v103, v147, v103, v253 op_sel:[1,1,0] op_sel_hi:[0,1,1] neg_hi:[0,1,0]
    v_pk_mul_f16 v246, v148, v104 op_sel_hi:[1,0]
    ds_read_b128 v[160:163], v28 offset:64
    v_mfma_f32_16x16x32_f16 v[136:139], v[120:123], v[84:87], 0
    v_pk_fma_f16 v247, v245, v244, v247 op_sel:[1,1,0] op_sel_hi:[0,1,1] neg_lo:[0,1,0]
    ds_read_b128 v[164:167], v28 offset:128
    v_pk_mul_f16 v255, v250, v252 op_sel_hi:[1,0]
    v_pk_fma_f16 v255, v250, v252, v255 op_sel:[1,1,0] op_sel_hi:[0,1,1] neg_lo:[0,1,0]
    v_pk_mul_f16 v254, v247, v252 op_sel_hi:[1,0]
    ds_read_b128 v[168:171], v28 offset:192
    v_pk_fma_f16 v254, v247, v252, v254 op_sel:[1,1,0] op_sel_hi:[0,1,1] neg_lo:[0,1,0]
    v_pk_mul_f16 v253, v255, v244 op_sel_hi:[1,0]
    v_pk_fma_f16 v253, v255, v244, v253 op_sel:[1,1,0] op_sel_hi:[0,1,1] neg_lo:[0,1,0]
    s_mov_b32 m0, s51
    s_nop 0
    ds_write_addtid_b32 v251 offset:2016
    v_mfma_f32_16x16x32_f16 v[156:159], v[116:119], v[100:103], v[156:159]
    v_pk_mul_f16 v95, v149, v105 op_sel_hi:[1,0]
    ds_read_b128 v[84:87], v31 offset:2016
    v_pk_fma_f16 v104, v148, v104, v246 op_sel:[1,1,0] op_sel_hi:[0,1,1] neg_hi:[0,1,0]
    v_pk_fma_f16 v105, v149, v105, v95 op_sel:[1,1,0] op_sel_hi:[0,1,1] neg_hi:[0,1,0]
    v_pk_mul_f16 v94, v150, v106 op_sel_hi:[1,0]
    ds_write_addtid_b32 v250 offset:3456
    v_mfma_f32_16x16x32_f16 v[108:111], v[124:127], v[140:143], v[108:111]
    v_pk_mul_f16 v251, v151, v107 op_sel_hi:[1,0]
    ds_read_b128 v[116:119], v31 offset:2080
    v_pk_fma_f16 v106, v150, v106, v94 op_sel:[1,1,0] op_sel_hi:[0,1,1] neg_hi:[0,1,0]
    v_pk_fma_f16 v107, v151, v107, v251 op_sel:[1,1,0] op_sel_hi:[0,1,1] neg_hi:[0,1,0]
    v_pk_mul_f16 v246, v255, v93 op_sel_hi:[1,0]
    s_waitcnt lgkmcnt(2)
    ds_write_addtid_b32 v247 offset:4320
    v_mfma_f32_16x16x32_f16 v[136:139], v[124:127], v[96:99], v[136:139]
    v_pk_mul_f16 v250, v112, v84 op_sel_hi:[1,0]
    ds_read_b128 v[120:123], v31 offset:2144
    v_pk_mul_f16 v95, v113, v85 op_sel_hi:[1,0]
    v_pk_fma_f16 v84, v112, v84, v250 op_sel:[1,1,0] op_sel_hi:[0,1,1] neg_hi:[0,1,0]
    v_pk_fma_f16 v85, v113, v85, v95 op_sel:[1,1,0] op_sel_hi:[0,1,1] neg_hi:[0,1,0]
    ds_write_addtid_b32 v245 offset:2592
    v_mfma_f32_16x16x32_f16 v[156:159], v[64:67], v[104:107], v[156:159]
    v_pk_mul_f16 v251, v114, v86 op_sel_hi:[1,0]
    ds_read_b128 v[96:99], v31 offset:2208
    v_pk_mul_f16 v247, v115, v87 op_sel_hi:[1,0]
    v_pk_fma_f16 v86, v114, v86, v251 op_sel:[1,1,0] op_sel_hi:[0,1,1] neg_hi:[0,1,0]
    v_pk_fma_f16 v87, v115, v87, v247 op_sel:[1,1,0] op_sel_hi:[0,1,1] neg_hi:[0,1,0]
    ds_write_addtid_b32 v255 offset:3744
    v_mfma_f32_16x16x32_f16 v[108:111], v[128:131], v[144:147], v[108:111]
    buffer_load_dwordx4 v[76:79], v49, s[36:39], s47 offen offset:0 nt
    buffer_load_dwordx4 v[80:83], v49, s[36:39], s47 offen offset:2048 nt
    s_waitcnt lgkmcnt(3)
    v_pk_mul_f16 v250, v160, v116 op_sel_hi:[1,0]
    ds_write_addtid_b32 v254 offset:4032
    v_pk_mul_f16 v251, v161, v117 op_sel_hi:[1,0]
    v_pk_fma_f16 v116, v160, v116, v250 op_sel:[1,1,0] op_sel_hi:[0,1,1] neg_hi:[0,1,0]
    v_pk_fma_f16 v117, v161, v117, v251 op_sel:[1,1,0] op_sel_hi:[0,1,1] neg_hi:[0,1,0]
    ds_write_addtid_b32 v252 offset:4608
    v_mfma_f32_16x16x32_f16 v[136:139], v[128:131], v[100:103], v[136:139]
    v_pk_mul_f16 v247, v162, v118 op_sel_hi:[1,0]
    ds_write_addtid_b32 v253 offset:5472
    v_pk_mul_f16 v95, v163, v119 op_sel_hi:[1,0]
    v_pk_fma_f16 v118, v162, v118, v247 op_sel:[1,1,0] op_sel_hi:[0,1,1] neg_hi:[0,1,0]
    v_pk_fma_f16 v119, v163, v119, v95 op_sel:[1,1,0] op_sel_hi:[0,1,1] neg_hi:[0,1,0]
    ds_write_addtid_b32 v248 offset:288
    v_mfma_f32_16x16x32_f16 v[108:111], v[132:135], v[148:151], v[108:111]
    v_pk_mul_f16 v252, v164, v120 op_sel_hi:[1,0]
    ds_write_addtid_b32 v249 offset:576
    v_pk_fma_f16 v246, v255, v93, v246 op_sel:[1,1,0] op_sel_hi:[0,1,1] neg_lo:[0,1,0]
    v_pk_mul_f16 v251, v165, v121 op_sel_hi:[1,0]
    v_pk_fma_f16 v120, v164, v120, v252 op_sel:[1,1,0] op_sel_hi:[0,1,1] neg_hi:[0,1,0]
    ds_write_addtid_b32 v246 offset:6336
    v_mfma_f32_16x16x32_f16 v[136:139], v[132:135], v[104:107], v[136:139]
    v_pk_mul_f16 v250, v254, v244 op_sel_hi:[1,0]
    s_setprio 1
    ds_write_addtid_b32 v244 offset:1152
    v_pk_fma_f16 v250, v254, v244, v250 op_sel:[1,1,0] op_sel_hi:[0,1,1] neg_lo:[0,1,0]
    v_pk_mul_f16 v255, v253, v93 op_sel_hi:[1,0]
    v_pk_fma_f16 v255, v253, v93, v255 op_sel:[1,1,0] op_sel_hi:[0,1,1] neg_lo:[0,1,0]
    ds_write_addtid_b32 v250 offset:5184
    v_pk_mul_f16 v252, v254, v93 op_sel_hi:[1,0]
    v_pk_fma_f16 v252, v254, v93, v252 op_sel:[1,1,0] op_sel_hi:[0,1,1] neg_lo:[0,1,0]
    v_pk_fma_f16 v121, v165, v121, v251 op_sel:[1,1,0] op_sel_hi:[0,1,1] neg_hi:[0,1,0]
    ds_write_addtid_b32 v255 offset:6912
    v_pk_mul_f16 v247, v246, v93 op_sel_hi:[1,0]
    v_pk_fma_f16 v247, v246, v93, v247 op_sel:[1,1,0] op_sel_hi:[0,1,1] neg_lo:[0,1,0]
    v_pk_mul_f16 v253, v166, v122 op_sel_hi:[1,0]
    ds_write_addtid_b32 v252 offset:6048
    v_pk_mul_f16 v254, v255, v93 op_sel_hi:[1,0]
    v_pk_fma_f16 v254, v255, v93, v254 op_sel:[1,1,0] op_sel_hi:[0,1,1] neg_lo:[0,1,0]
    v_pk_mul_f16 v251, v167, v123 op_sel_hi:[1,0]
    ds_write_addtid_b32 v247 offset:4896
    v_pk_mul_f16 v250, v247, v93 op_sel_hi:[1,0]
    v_pk_fma_f16 v250, v247, v93, v250 op_sel:[1,1,0] op_sel_hi:[0,1,1] neg_lo:[0,1,0]
    v_pk_fma_f16 v122, v166, v122, v253 op_sel:[1,1,0] op_sel_hi:[0,1,1] neg_hi:[0,1,0]
    ds_write_addtid_b32 v254 offset:5760
    v_pk_mul_f16 v246, v245, v249 op_sel_hi:[1,0]
    v_pk_fma_f16 v246, v245, v249, v246 op_sel:[1,1,0] op_sel_hi:[0,1,1] neg_lo:[0,1,0]
    v_pk_fma_f16 v123, v167, v123, v251 op_sel:[1,1,0] op_sel_hi:[0,1,1] neg_hi:[0,1,0]
    s_waitcnt lgkmcnt(2)
    ds_write_addtid_b32 v250 offset:6624
    v_pk_mul_f16 v247, v168, v96 op_sel_hi:[1,0]
    v_pk_mul_f16 v63, v169, v97 op_sel_hi:[1,0]
    v_pk_fma_f16 v96, v168, v96, v247 op_sel:[1,1,0] op_sel_hi:[0,1,1] neg_hi:[0,1,0]
    ds_write_addtid_b32 v246 offset:2880
    v_pk_fma_f16 v97, v169, v97, v63 op_sel:[1,1,0] op_sel_hi:[0,1,1] neg_hi:[0,1,0]
    v_pk_mul_f16 v251, v170, v98 op_sel_hi:[1,0]
    v_pk_mul_f16 v250, v171, v99 op_sel_hi:[1,0]
    ds_read_b128 v[48:51], v30 offset:2592
    v_pk_fma_f16 v98, v170, v98, v251 op_sel:[1,1,0] op_sel_hi:[0,1,1] neg_hi:[0,1,0]
    v_pk_fma_f16 v99, v171, v99, v250 op_sel:[1,1,0] op_sel_hi:[0,1,1] neg_hi:[0,1,0]
    v_pk_mul_f16 v247, v249, v248 op_sel_hi:[1,0]
    ds_read_b128 v[64:67], v30 offset:2656
    v_pk_fma_f16 v247, v249, v248, v247 op_sel:[1,1,0] op_sel_hi:[0,1,1] neg_lo:[0,1,0]
    v_pk_mul_f16 v63, v245, v248 op_sel_hi:[1,0]
    v_pk_fma_f16 v63, v245, v248, v63 op_sel:[1,1,0] op_sel_hi:[0,1,1] neg_lo:[0,1,0]
    ds_write_addtid_b32 v247 offset:864
    v_pk_mul_f16 v251, v249, v244 op_sel_hi:[1,0]
    v_pk_fma_f16 v251, v249, v244, v251 op_sel:[1,1,0] op_sel_hi:[0,1,1] neg_lo:[0,1,0]
    v_pk_mul_f16 v250, v246, v248 op_sel_hi:[1,0]
    s_waitcnt lgkmcnt(2)
    ds_write_addtid_b32 v63 offset:2304
    v_mfma_f32_16x16x32_f16 v[152:155], v[48:51], v[112:115], v[152:155]
    s_setprio 0
    v_pk_fma_f16 v250, v246, v248, v250 op_sel:[1,1,0] op_sel_hi:[0,1,1] neg_lo:[0,1,0]
    v_pk_mul_f16 v247, v246, v244 op_sel_hi:[1,0]
    v_pk_fma_f16 v247, v246, v244, v247 op_sel:[1,1,0] op_sel_hi:[0,1,1] neg_lo:[0,1,0]
    s_waitcnt lgkmcnt(2)
    ds_read_b128 v[92:95], v30 offset:2784
    v_mfma_f32_16x16x32_f16 v[152:155], v[64:67], v[160:163], v[152:155]
    ds_read_b128 v[100:103], v30 offset:2720
    ds_write_addtid_b32 v247 offset:1440
    v_mfma_f32_16x16x32_f16 v[156:159], v[48:51], v[84:87], v[156:159]
    ds_write_addtid_b32 v250 offset:3168
    ds_write_addtid_b32 v251 offset:1728
    s_mov_b32 m0, s50
    v_mfma_f32_16x16x32_f16 v[156:159], v[64:67], v[116:119], v[156:159]
    ds_read_b128 v[104:107], v29 offset:192
    s_waitcnt lgkmcnt(4)
    v_mfma_f32_16x16x32_f16 v[152:155], v[100:103], v[164:167], v[152:155]
    ds_read_b128 v[48:51], v29 offset:128
    v_mfma_f32_16x16x32_f16 v[152:155], v[92:95], v[168:171], v[152:155]
    ds_read_b128 v[124:127], v29 offset:0
    s_waitcnt vmcnt(2)
    v_perm_b32 v63, v73, v69, s45
    v_perm_b32 v57, v72, v68, s44
    v_perm_b32 v56, v73, v69, s44
    v_perm_b32 v54, v74, v70, s45
    v_mfma_f32_16x16x32_f16 v[156:159], v[92:95], v[96:99], v[156:159]
    ds_write_addtid_b32 v56 offset:34560
    v_perm_b32 v47, v75, v71, s45
    v_perm_b32 v46, v72, v68, s45
    v_mfma_f32_16x16x32_f16 v[156:159], v[100:103], v[120:123], v[156:159]
    ds_write_addtid_b32 v46 offset:29952
    ds_read_b128 v[64:67], v29 offset:64
    ds_write_addtid_b32 v47 offset:57600
    s_waitcnt lgkmcnt(4)
    v_mfma_f32_16x16x32_f16 v[108:111], v[48:51], v[164:167], v[108:111]
    ds_write_b64 v39, v[60:61] offset:8
    v_perm_b32 v73, v74, v70, s44
    v_mfma_f32_16x16x32_f16 v[136:139], v[124:127], v[84:87], v[136:139]
    ds_write_addtid_b32 v73 offset:43776
    ds_write_addtid_b32 v63 offset:39168
    ds_write_addtid_b32 v54 offset:48384
    v_mul_f32 v68, v158, v90
    v_mul_f32 v69, v159, v90
    v_perm_b32 v74, v75, v71, s44
    v_mfma_f32_16x16x32_f16 v[108:111], v[124:127], v[112:115], v[108:111]
    ds_write_addtid_b32 v74 offset:52992
    ds_write_addtid_b32 v57 offset:25344
    v_mul_f32 v157, v157, v91
    v_mul_f32 v158, v158, v88
    v_mul_f32 v159, v159, v88
    s_waitcnt lgkmcnt(4)
    v_mfma_f32_16x16x32_f16 v[136:139], v[64:67], v[116:119], v[136:139]
    v_mul_f32 v153, v153, v91
    v_cvt_pk_bf16_f32 v71, v153, v157
    v_mfma_f32_16x16x32_f16 v[108:111], v[64:67], v[160:163], v[108:111]
    ds_write_b16_d16_hi v36, v71 offset:92
    s_waitcnt lgkmcnt(1)
    s_barrier
    ds_read_b128 v[28:31], v1 offset:464
    v_mfma_f32_16x16x32_f16 v[108:111], v[104:107], v[168:171], v[108:111]
    v_cvt_pk_bf16_f32 v91, v158, v159
    v_writelane_b32 v91, 0, 47
    ds_write_b16 v36, v71 offset:60
    v_mfma_f32_16x16x32_f16 v[136:139], v[48:51], v[120:123], v[136:139]
    v_mul_f32 v155, v155, v88
    v_mul_f32 v154, v154, v88
    v_cvt_pk_bf16_f32 v70, v154, v155
    ds_write2_b32 v35, v70, v91 offset0:0 offset1:16
    v_mfma_f32_16x16x32_f16 v[136:139], v[104:107], v[96:99], v[136:139]
    v_mul_f32 v111, v111, v90
    v_mul_f32 v152, v152, v90
    v_cvt_pk_bf16_f32 v68, v68, v69
    v_mul_f32 v156, v156, v90
    v_readlane_b32 s68, v68, 46
    v_readlane_b32 s69, v68, 47
    s_nop 0
    s_pack_hh_b32_b16 s68, s68, s69
    ds_read_b128 v[48:51], v1 offset:448
    v_mul_f32 v136, v136, v90
    ds_read_b128 v[64:67], v1 offset:960
    ds_read_b128 v[72:75], v1 offset:976
    s_waitcnt lgkmcnt(3)
    v_mfma_f32_16x16x32_bf16 v[84:87], v[28:31], v[20:23], 0
    v_mul_f32 v137, v137, v90
    v_perm_b32 v94, s68, s68, v26
    s_setprio 3
    v_cvt_pk_bf16_f32 v89, v137, v136
    v_readlane_b32 s54, v68, 15
    v_mul_f32 v139, v139, v90
    s_waitcnt lgkmcnt(2)
    v_mfma_f32_16x16x32_bf16 v[28:31], v[48:51], v[16:19], 0
    v_mul_f32 v138, v138, v90
    v_cvt_pk_bf16_f32 v88, v139, v138
    s_waitcnt lgkmcnt(0)
    ds_write2_b32 v34, v88, v89 offset0:1 offset1:2
    v_mfma_f32_16x16x32_bf16 v[96:99], v[72:75], v[12:15], 0
    ds_write_b64 v32, v[88:89] offset:8
    v_mfma_f32_16x16x32_bf16 v[100:103], v[72:75], v[8:11], 0
    ds_read_b128 v[48:51], v1 offset:1488
    v_mul_f32 v110, v110, v90
    ds_read_b128 v[104:107], v1 offset:1472
    v_mfma_f32_16x16x32_bf16 v[112:115], v[64:67], v[8:11], 0
    v_mul_f32 v109, v109, v90
    v_cvt_pk_bf16_f32 v88, v156, v139
    s_nop 1
    v_cvt_pk_bf16_f32 v116, v100, v96
    v_cvt_pk_bf16_f32 v71, v110, v109
    v_cvt_pk_bf16_f32 v89, v138, v137
    v_mfma_f32_16x16x32_bf16 v[120:123], v[72:75], v[20:23], 0
    ds_write2_b32 v33, v88, v89 offset0:1 offset1:2
    v_cvt_pk_bf16_f32 v124, v84, v28
    v_fma_f32 v108, v108, v90, v62
    v_cvt_pk_bf16_f32 v127, v87, v31
    v_cvt_pk_bf16_f32 v128, v102, v98
    v_cvt_pk_bf16_f32 v125, v85, v29
    s_and_b32 s35, s32, 3
    v_pk_fma_f16 v42, v42, s53, v59 op_sel_hi:[1,0,1]
    v_mov_b32 v91, s54
    v_perm_b32 v93, s68, s68, v25
    s_lshl_b32 s35, s35, 5
    v_pk_fma_f16 v27, v19, s53, v42 op_sel:[0,1,0]
    v_cvt_pk_bf16_f32 v57, v109, v108
    v_mfma_f32_16x16x32_bf16 v[60:63], v[64:67], v[12:15], 0
    v_cvt_pk_bf16_f32 v70, v152, v111
    s_waitcnt lgkmcnt(0)
    ds_write_b64 v32, v[88:89] offset:3264
    v_cvt_pk_bf16_f32 v118, v101, v97
    v_cvt_pk_bf16_f32 v56, v111, v110
    v_readlane_b32 s53, v68, 14
    v_cvt_pk_bf16_f32 v126, v86, v30
    v_mfma_f32_16x16x32_bf16 v[72:75], v[104:107], v[8:11], 0
    ds_write_b64 v32, v[56:57] offset:264
    v_cvt_pk_bf16_f32 v129, v114, v62
    s_add_u32 s35, s35, s51
    v_lshl_add_u32 v42, v43, 3, s35
    ds_write2_b32 v33, v70, v71 offset0:65 offset1:66
    s_lshl_b32 s35, s32, 16
    s_add_u32 s35, s35, s30
    v_mfma_f32_16x16x32_bf16 v[28:31], v[48:51], v[8:11], 0
    v_mad_u32_u24 v5, v45, 9, v42
    v_lshl_add_u32 v42, v40, 11, s35
    v_cvt_pk_bf16_f32 v130, v103, v99
    v_lshl_add_u32 v7, v53, 25, v42
    v_and_b32 v42, 12, v0
    v_mfma_f32_16x16x32_bf16 v[84:87], v[64:67], v[16:19], 0
    ds_read2_b32 v[108:109], v4 offset0:3 offset1:2
    ds_write2_b32 v34, v56, v57 offset0:65 offset1:66
    s_lshl_b32 s35, s32, 4
    v_mul_u32_u24 v42, 1808, v42
    v_add3_u32 v58, v55, v42, s35
    v_mfma_f32_16x16x32_bf16 v[44:47], v[104:107], v[16:19], 0
    s_movk_i32 s35, 144
    ds_read_b128 v[64:67], v1 offset:1984
    v_mfma_f32_16x16x32_bf16 v[96:99], v[48:51], v[12:15], 0
    v_cvt_pk_bf16_f32 v117, v112, v60
    v_cvt_pk_bf16_f32 v101, v121, v85
    ds_read_b128 v[40:43], v1 offset:2000
    ds_read_b64 v[134:135], v3 offset:376
    v_perm_b32 v92, s68, s68, v24
    v_mfma_f32_16x16x32_bf16 v[136:139], v[48:51], v[20:23], 0
    v_cvt_pk_bf16_f32 v103, v123, v87
    ds_write_b64 v32, v[70:71] offset:3520
    v_mad_u32_u24 v6, v52, s35, v58
    v_readlane_b32 s35, v57, 0
    s_mul_i32 s4, s31, 2621440
    v_cvt_pk_bf16_f32 v140, v28, v96
    s_pack_hh_b32_b16 s53, s53, s35
    v_perm_b32 v91, s53, v91, v38
    s_add_u32 s5, s4, 524288
    v_cvt_pk_bf16_f32 v32, v30, v98
    v_mfma_f32_16x16x32_bf16 v[48:51], v[104:107], v[12:15], 0
    ds_read_b64 v[132:133], v3 offset:384
    ds_write_b16 v37, v91
    s_setprio 2
    v_cvt_pk_bf16_f32 v131, v115, v63
    v_cvt_pk_bf16_f32 v100, v120, v84
    v_cvt_pk_bf16_f32 v119, v113, v61
    v_perm_b32 v95, s68, s68, v27
    v_cvt_pk_bf16_f32 v52, v136, v44
    s_add_u32 s7, s4, 1572864
    v_cvt_pk_bf16_f32 v54, v138, v46
    v_cvt_pk_bf16_f32 v55, v139, v47
    ds_read_b64 v[38:39], v3 offset:360
    v_cvt_pk_bf16_f32 v142, v29, v97
    v_cvt_pk_bf16_f32 v141, v72, v48
    s_waitcnt lgkmcnt(1)
    ds_read_b64 v[24:25], v3 offset:240
    v_cvt_pk_bf16_f32 v34, v31, v99
    v_cvt_pk_bf16_f32 v102, v122, v86
    v_cvt_pk_bf16_f32 v33, v74, v50
    v_cvt_pk_bf16_f32 v53, v137, v45
    v_mfma_f32_16x16x32_bf16 v[56:59], v[40:43], v[12:15], 0
    ds_read2_b32 v[60:61], v4 offset0:19 offset1:18
    ds_read2_b32 v[110:111], v4 offset0:1 offset1:0
    v_mfma_f32_16x16x32_bf16 v[28:31], v[40:43], v[8:11], 0
    v_cvt_pk_bf16_f32 v143, v73, v49
    v_mfma_f32_16x16x32_bf16 v[68:71], v[64:67], v[8:11], 0
    ds_read_b64 v[36:37], v3 offset:368
    v_cvt_pk_bf16_f32 v35, v75, v51
    v_mfma_f32_16x16x32_bf16 v[44:47], v[64:67], v[12:15], 0
    ds_read2_b32 v[62:63], v4 offset0:17 offset1:16
    v_mfma_f32_16x16x32_bf16 v[84:87], v[64:67], v[16:19], 0
    ds_read_b64 v[90:91], v2 offset:712
    v_mfma_f32_16x16x32_bf16 v[96:99], v[40:43], v[20:23], 0
    ds_read_b64 v[106:107], v3 offset:120
    ds_read_b64 v[104:105], v3 offset:128
    ds_read_b64 v[50:51], v2 offset:72
    v_cvt_pk_bf16_f32 v74, v29, v57
    s_waitcnt lgkmcnt(4)
    ds_read_b64 v[18:19], v3 offset:248
    v_mfma_f32_16x16x32_bf16 v[64:67], v[124:127], v[60:63], 0
    v_cvt_pk_bf16_f32 v72, v28, v56
    v_cvt_pk_bf16_f32 v73, v68, v44
    v_mfma_f32_16x16x32_bf16 v[64:67], v[116:119], v[132:135], v[64:67]
    ds_read_b64 v[48:49], v2 offset:64
    v_cvt_pk_bf16_f32 v20, v96, v84
    v_mfma_f32_16x16x32_bf16 v[64:67], v[100:103], v[108:111], v[64:67]
    ds_read_b128 v[40:43], v1 offset:992
    v_mfma_f32_16x16x32_bf16 v[64:67], v[128:131], v[36:39], v[64:67]
    ds_read_b128 v[112:115], v1 offset:2016
    v_cvt_pk_bf16_f32 v116, v30, v58
    ds_read_b64 v[120:121], v3 offset:112
    v_cvt_pk_bf16_f32 v119, v71, v47
    v_mfma_f32_16x16x32_bf16 v[136:139], v[140:143], v[132:135], 0
    ds_read_b64 v[146:147], v2 offset:136
    ds_read_b64 v[122:123], v3 offset:104
    s_setprio 1
    v_cvt_pk_bf16_f32 v22, v98, v86
    v_mfma_f32_16x16x32_bf16 v[136:139], v[32:35], v[36:39], v[136:139]
    s_add_u32 s8, s4, 2097152
    ds_read_b64 v[128:129], v2 offset:576
    ds_read_b64 v[16:17], v3 offset:256
    ds_read_b64 v[150:151], v2 offset:8
    v_cvt_pk_bf16_f32 v21, v97, v85
    ds_read_b64 v[130:131], v2 offset:584
    ds_read_b64 v[144:145], v2 offset:128
    ds_read_b64 v[148:149], v2 offset:0
    ds_read_b64 v[26:27], v3 offset:232
    v_cvt_pk_bf16_f32 v118, v31, v59
    v_cvt_pk_bf16_f32 v117, v70, v46
    v_cvt_pk_bf16_f32 v75, v69, v45
    s_waitcnt vmcnt(0)
    v_perm_b32 v0, v82, v78, s44
    v_perm_b32 v255, v83, v79, s45
    s_add_u32 s6, s4, 1048576
    v_perm_b32 v254, v81, v77, s44
    v_perm_b32 v253, v81, v77, s45
    ds_write_addtid_b32 v253 offset:41216
    ds_write_addtid_b32 v0 offset:45824
    v_mfma_f32_16x16x32_bf16 v[136:139], v[100:103], v[60:63], v[136:139]
    v_perm_b32 v252, v82, v78, s45
    v_perm_b32 v3, v83, v79, s44
    v_perm_b32 v251, v80, v76, s44
    s_waitcnt lgkmcnt(2)
    v_mfma_f32_16x16x32_bf16 v[64:67], v[92:95], v[40:43], v[64:67]
    ds_read_b64 v[30:31], v2 offset:648
    ds_write_addtid_b32 v255 offset:59648
    v_mfma_f32_16x16x32_bf16 v[64:67], v[32:35], v[24:27], v[64:67]
    ds_read_b64 v[46:47], v2 offset:776
    v_perm_b32 v253, v80, v76, s45
    ds_read_b64 v[58:59], v2 offset:264
    ds_write_addtid_b32 v251 offset:27392
    v_mfma_f32_16x16x32_bf16 v[136:139], v[72:75], v[16:19], v[136:139]
    s_setprio 0
    ds_write_addtid_b32 v254 offset:36608
    ds_read_b64 v[28:29], v2 offset:640
    v_mfma_f32_16x16x32_bf16 v[64:67], v[140:143], v[16:19], v[64:67]
    ds_write_addtid_b32 v252 offset:50432
    ds_write_addtid_b32 v253 offset:32000
    v_mfma_f32_16x16x32_bf16 v[136:139], v[116:119], v[24:27], v[136:139]
    ds_write_addtid_b32 v3 offset:55040
    ds_read_b64 v[56:57], v2 offset:256
    v_mfma_f32_16x16x32_bf16 v[32:35], v[72:75], v[132:135], 0
    ds_read_b64 v[88:89], v2 offset:704
    ds_read_b64 v[42:43], v2 offset:200
    v_mfma_f32_16x16x32_bf16 v[64:67], v[72:75], v[104:107], v[64:67]
    ds_read_b64 v[44:45], v2 offset:768
    ds_read_b64 v[40:41], v2 offset:192
    ds_read_b64 v[70:71], v2 offset:520
    v_mfma_f32_16x16x32_bf16 v[64:67], v[116:119], v[120:123], v[64:67]
    s_waitcnt lgkmcnt(6)
    s_barrier
    ds_read_b128 v[76:79], v1 offset:2592
    v_mfma_f32_16x16x32_bf16 v[32:35], v[92:95], v[112:115], v[32:35]
    ds_read_b128 v[72:75], v1 offset:2080
    v_mfma_f32_16x16x32_bf16 v[64:67], v[148:151], v[112:115], v[64:67]
    ds_read_b128 v[80:83], v1 offset:2208
    v_cvt_pk_bf16_f32 v23, v99, v87
    s_waitcnt lgkmcnt(2)
    v_mfma_f32_16x16x32_bf16 v[136:139], v[48:51], v[76:79], v[136:139]
    ds_read_b128 v[132:135], v1 offset:2656
    s_waitcnt lgkmcnt(2)
    v_mfma_f32_16x16x32_bf16 v[64:67], v[48:51], v[72:75], v[64:67]
    ds_read_b128 v[140:143], v1 offset:2720
    s_waitcnt lgkmcnt(2)
    v_mfma_f32_16x16x32_bf16 v[64:67], v[40:43], v[80:83], v[64:67]
    ds_read_b128 v[112:115], v1 offset:2848
    s_waitcnt lgkmcnt(1)
    v_mfma_f32_16x16x32_bf16 v[136:139], v[40:43], v[140:143], v[136:139]
    s_setprio 2
    ds_read_b128 v[84:87], v1 offset:2784
    v_mfma_f32_16x16x32_bf16 v[32:35], v[116:119], v[36:39], v[32:35]
    ds_read_b128 v[72:75], v1 offset:2144
    v_mfma_f32_16x16x32_bf16 v[136:139], v[144:147], v[132:135], v[136:139]
    ds_read_b64 v[80:81], v2 offset:320
    ds_read_b64 v[96:97], v2 offset:832
    ds_read_b64 v[82:83], v2 offset:328
    v_mfma_f32_16x16x32_bf16 v[64:67], v[28:31], v[132:135], v[64:67]
    ds_read_b128 v[36:39], v1 offset:2336
    v_mfma_f32_16x16x32_bf16 v[64:67], v[88:91], v[140:143], v[64:67]
    s_waitcnt lgkmcnt(4)
    v_mfma_f32_16x16x32_bf16 v[64:67], v[144:147], v[72:75], v[64:67]
    ds_read_b128 v[116:119], v1 offset:2272
    s_waitcnt lgkmcnt(2)
    v_mfma_f32_16x16x32_bf16 v[136:139], v[80:83], v[112:115], v[136:139]
    ds_read_b64 v[154:155], v2 offset:392
    ds_read_b64 v[152:153], v2 offset:384
    v_mfma_f32_16x16x32_bf16 v[64:67], v[128:131], v[76:79], v[64:67]
    ds_read_b128 v[132:135], v1 offset:2912
    s_waitcnt lgkmcnt(4)
    v_mfma_f32_16x16x32_bf16 v[64:67], v[80:83], v[36:39], v[64:67]
    ds_read_b64 v[98:99], v2 offset:840
    v_mfma_f32_16x16x32_bf16 v[64:67], v[44:47], v[84:87], v[64:67]
    ds_read_b64 v[74:75], v2 offset:904
    ds_read_b64 v[72:73], v2 offset:896
    s_waitcnt lgkmcnt(6)
    v_mfma_f32_16x16x32_bf16 v[64:67], v[56:59], v[116:119], v[64:67]
    ds_read_b64 v[78:79], v2 offset:968
    ds_read_b64 v[76:77], v2 offset:960
    v_mfma_f32_16x16x32_bf16 v[136:139], v[56:59], v[84:87], v[136:139]
    ds_read_b64 v[36:37], v2 offset:448
    ds_read_b64 v[38:39], v2 offset:456
    v_mfma_f32_16x16x32_bf16 v[136:139], v[52:55], v[108:111], v[136:139]
    s_waitcnt lgkmcnt(6)
    v_mfma_f32_16x16x32_bf16 v[136:139], v[152:155], v[132:135], v[136:139]
    ds_read_b128 v[116:119], v1 offset:2464
    v_mfma_f32_16x16x32_bf16 v[64:67], v[96:99], v[112:115], v[64:67]
    ds_read_b128 v[84:87], v1 offset:2976
    s_setprio 1
    ds_read_b128 v[140:143], v1 offset:2400
    s_waitcnt lgkmcnt(5)
    v_mfma_f32_16x16x32_bf16 v[64:67], v[72:75], v[132:135], v[64:67]
    ds_read_b128 v[156:159], v1 offset:2528
    s_waitcnt lgkmcnt(2)
    v_mfma_f32_16x16x32_bf16 v[136:139], v[36:39], v[84:87], v[136:139]
    ds_read_b64 v[68:69], v2 offset:512
    ds_read_b64 v[114:115], v2 offset:1032
    v_mfma_f32_16x16x32_bf16 v[64:67], v[76:79], v[84:87], v[64:67]
    ds_read_b128 v[160:163], v1 offset:3040
    v_mfma_f32_16x16x32_bf16 v[64:67], v[36:39], v[116:119], v[64:67]
    ds_read_b64 v[112:113], v2 offset:1024
    s_waitcnt lgkmcnt(5)
    v_mfma_f32_16x16x32_bf16 v[64:67], v[152:155], v[140:143], v[64:67]
    s_setprio 2
    s_waitcnt lgkmcnt(3)
    v_mfma_f32_16x16x32_bf16 v[64:67], v[68:71], v[156:159], v[64:67]
    ds_read_b128 v[84:87], v1 offset:3360
    ds_read_b128 v[132:135], v1 offset:3104
    s_waitcnt lgkmcnt(2)
    v_mfma_f32_16x16x32_bf16 v[64:67], v[112:115], v[160:163], v[64:67]
    v_mfma_f32_16x16x32_bf16 v[32:35], v[148:151], v[160:163], v[32:35]
    ds_read_b128 v[116:119], v1 offset:2512
    s_setprio 0
    s_nop 4
    v_cvt_pk_bf16_f32 v2, v64, v65
    s_waitcnt lgkmcnt(0)
    ds_read_b128 v[140:143], v1 offset:2496
    v_cvt_pk_bf16_f32 v3, v66, v67
    v_mfma_f32_16x16x32_bf16 v[136:139], v[148:151], v[156:159], v[136:139]
    v_mfma_f32_16x16x32_bf16 v[164:167], v[116:119], v[8:11], 0
    ds_write_b64 v5, v[2:3] offset:0
    v_mfma_f32_16x16x32_bf16 v[168:171], v[116:119], v[12:15], 0
    ds_read_b128 v[172:175], v1 offset:3296
    v_mfma_f32_16x16x32_bf16 v[32:35], v[48:51], v[132:135], v[32:35]
    ds_read_b128 v[64:67], v1 offset:3424
    s_waitcnt lgkmcnt(3)
    v_mfma_f32_16x16x32_bf16 v[148:151], v[140:143], v[12:15], 0
    ds_read_b128 v[156:159], v1 offset:3232
    v_mfma_f32_16x16x32_bf16 v[176:179], v[140:143], v[8:11], 0
    s_waitcnt lgkmcnt(3)
    s_barrier
    ds_read_b64_tr_b16 v[118:119], v6 offset:28800
    v_mfma_f32_16x16x32_bf16 v[32:35], v[80:83], v[84:87], v[32:35]
    ds_read_b64_tr_b16 v[116:117], v6 offset:0
    s_waitcnt lgkmcnt(2)
    v_mfma_f32_16x16x32_bf16 v[32:35], v[40:43], v[156:159], v[32:35]
    v_cvt_pk_bf16_f32 v48, v166, v170
    s_setprio 3
    v_mfma_f32_16x16x32_bf16 v[136:139], v[96:99], v[84:87], v[136:139]
    ds_read2_b32 v[140:141], v4 offset0:35 offset1:34
    v_cvt_pk_bf16_f32 v83, v177, v149
    v_mfma_f32_16x16x32_bf16 v[136:139], v[68:71], v[160:163], v[136:139]
    ds_read_b128 v[40:43], v1 offset:3168
    s_waitcnt lgkmcnt(2)
    buffer_store_dwordx4 v[116:119], v7, s[40:43], s4 offen
    s_waitcnt lgkmcnt(0)
    v_mfma_f32_16x16x32_bf16 v[32:35], v[144:147], v[40:43], v[32:35]
    v_cvt_pk_bf16_f32 v81, v176, v148
    v_cvt_pk_bf16_f32 v50, v167, v171
    v_mfma_f32_16x16x32_bf16 v[136:139], v[72:75], v[64:67], v[136:139]
    ds_read_b128 v[84:87], v1 offset:3488
    v_cvt_pk_bf16_f32 v82, v165, v169
    v_mfma_f32_16x16x32_bf16 v[136:139], v[44:47], v[172:175], v[136:139]
    ds_read2_b32 v[142:143], v4 offset0:33 offset1:32
    v_cvt_pk_bf16_f32 v80, v164, v168
    v_mfma_f32_16x16x32_bf16 v[136:139], v[28:31], v[40:43], v[136:139]
    ds_read_b128 v[116:119], v1 offset:1504
    v_mfma_f32_16x16x32_bf16 v[136:139], v[80:83], v[104:107], v[136:139]
    ds_read_b128 v[144:147], v1 offset:3024
    v_mfma_f32_16x16x32_bf16 v[136:139], v[128:131], v[132:135], v[136:139]
    ds_read_b128 v[160:163], v1 offset:3552
    s_setprio 2
    v_cvt_pk_bf16_f32 v51, v179, v151
    s_waitcnt lgkmcnt(3)
    v_mfma_f32_16x16x32_bf16 v[136:139], v[124:127], v[140:143], v[136:139]
    ds_read_b128 v[40:43], v1 offset:3680
    v_mfma_f32_16x16x32_bf16 v[136:139], v[88:91], v[156:159], v[136:139]
    ds_read_b128 v[132:135], v1 offset:4064
    s_waitcnt lgkmcnt(2)
    v_mfma_f32_16x16x32_bf16 v[136:139], v[112:115], v[160:163], v[136:139]
    v_mfma_f32_16x16x32_bf16 v[136:139], v[76:79], v[84:87], v[136:139]
    v_cvt_pk_bf16_f32 v49, v178, v150
    v_mfma_f32_16x16x32_bf16 v[136:139], v[92:95], v[116:119], v[136:139]
    ds_read_b128 v[164:167], v1 offset:3008
    v_mfma_f32_16x16x32_bf16 v[136:139], v[48:51], v[120:123], v[136:139]
    ds_read_b128 v[156:159], v1 offset:4000
    s_nop 6
    v_cvt_pk_bf16_f32 v3, v138, v139
    v_cvt_pk_bf16_f32 v2, v136, v137
    v_mfma_f32_16x16x32_bf16 v[148:151], v[144:147], v[12:15], 0
    s_setprio 0
    ds_write_b64 v5, v[2:3] offset:576
    v_mfma_f32_16x16x32_bf16 v[92:95], v[144:147], v[8:11], 0
    ds_read2_b32 v[118:119], v4 offset0:49 offset1:48
    s_waitcnt lgkmcnt(2)
    v_mfma_f32_16x16x32_bf16 v[168:171], v[164:167], v[12:15], 0
    ds_read_b128 v[136:139], v1 offset:3936
    v_mfma_f32_16x16x32_bf16 v[32:35], v[152:155], v[64:67], v[32:35]
    s_setprio 2
    v_mfma_f32_16x16x32_bf16 v[32:35], v[36:39], v[84:87], v[32:35]
    s_waitcnt lgkmcnt(2)
    s_barrier
    v_mfma_f32_16x16x32_bf16 v[144:147], v[164:167], v[8:11], 0
    ds_read_b64_tr_b16 v[12:13], v6 offset:576
    v_mfma_f32_16x16x32_bf16 v[32:35], v[100:103], v[140:143], v[32:35]
    ds_read_b64_tr_b16 v[14:15], v6 offset:29376
    v_mfma_f32_16x16x32_bf16 v[32:35], v[48:51], v[24:27], v[32:35]
    ds_read_b128 v[36:39], v1 offset:3616
    v_mfma_f32_16x16x32_bf16 v[32:35], v[76:79], v[156:159], v[32:35]
    ds_read_b128 v[8:11], v1 offset:3744
    s_setprio 1
    s_waitcnt lgkmcnt(2)
    buffer_store_dwordx4 v[12:15], v7, s[40:43], s5 offen
    v_mfma_f32_16x16x32_bf16 v[32:35], v[68:71], v[160:163], v[32:35]
    ds_read_b128 v[24:27], v1 offset:3808
    v_mfma_f32_16x16x32_bf16 v[32:35], v[20:23], v[108:111], v[32:35]
    ds_read_b128 v[48:51], v1 offset:3872
    v_mfma_f32_16x16x32_bf16 v[32:35], v[72:75], v[136:139], v[32:35]
    s_waitcnt lgkmcnt(2)
    v_mfma_f32_16x16x32_bf16 v[32:35], v[88:91], v[8:11], v[32:35]
    v_cvt_pk_bf16_f32 v13, v144, v168
    v_mfma_f32_16x16x32_bf16 v[32:35], v[52:55], v[60:63], v[32:35]
    v_cvt_pk_bf16_f32 v65, v146, v170
    v_cvt_pk_bf16_f32 v64, v94, v150
    v_mfma_f32_16x16x32_bf16 v[32:35], v[56:59], v[172:175], v[32:35]
    ds_read2_b32 v[116:117], v4 offset0:51 offset1:50
    v_mfma_f32_16x16x32_bf16 v[32:35], v[28:31], v[40:43], v[32:35]
    v_cvt_pk_bf16_f32 v15, v145, v169
    v_cvt_pk_bf16_f32 v66, v95, v151
    v_mfma_f32_16x16x32_bf16 v[32:35], v[80:83], v[16:19], v[32:35]
    v_cvt_pk_bf16_f32 v67, v147, v171
    s_waitcnt lgkmcnt(1)
    v_mfma_f32_16x16x32_bf16 v[32:35], v[96:99], v[48:51], v[32:35]
    v_cvt_pk_bf16_f32 v12, v92, v148
    v_cvt_pk_bf16_f32 v14, v93, v149
    v_mfma_f32_16x16x32_bf16 v[32:35], v[128:131], v[36:39], v[32:35]
    s_nop 0
    v_mfma_f32_16x16x32_bf16 v[32:35], v[12:15], v[104:107], v[32:35]
    v_mfma_f32_16x16x32_bf16 v[32:35], v[112:115], v[132:135], v[32:35]
    v_mfma_f32_16x16x32_bf16 v[32:35], v[44:47], v[24:27], v[32:35]
    v_mfma_f32_16x16x32_bf16 v[32:35], v[64:67], v[120:123], v[32:35]
    s_waitcnt lgkmcnt(0)
    v_mfma_f32_16x16x32_bf16 v[32:35], v[124:127], v[116:119], v[32:35]
    s_nop 7
    v_cvt_pk_bf16_f32 v255, v34, v35
    v_cvt_pk_bf16_f32 v254, v32, v33
    s_setprio 0
    ds_write_b64 v5, v[254:255] offset:1152
    s_waitcnt lgkmcnt(0)
    s_barrier
    ds_read_b64_tr_b16 v[0:1], v6 offset:1152
    ds_read_b64_tr_b16 v[2:3], v6 offset:29952
    s_waitcnt lgkmcnt(0)
    buffer_store_dwordx4 v[0:3], v7, s[40:43], s6 offen
    s_endpgm
.p2align 6
LtypeA:
    s_waitcnt vmcnt(6)
    v_lshlrev_b32 v95, 16, v57
    v_lshlrev_b32 v94, 16, v48
    v_mul_f32 v95, v95, v93
    s_mov_b32 s38, 0x280000
    v_fract_f32 v89, v95
    v_cos_f32 v50, v89
    v_sin_f32 v51, v89
    v_mul_f32 v94, v94, v92
    v_exp_f32 v88, v94
    s_nop 0
    v_pk_mul_f32 v[50:51], v[50:51], v[88:89] op_sel_hi:[1,0]
    v_pk_mul_f32 v[46:47], v[50:51], v[50:51] op_sel_hi:[1,0]
    v_cvt_pk_f16_f32 v63, v50, v51
    ds_write_addtid_b32 v63 offset:288
    v_pk_fma_f32 v[46:47], v[50:51], v[50:51], v[46:47] op_sel:[1,1,0] op_sel_hi:[0,1,1] neg_lo:[0,1,0]
    v_pk_mul_f32 v[254:255], v[46:47], v[46:47] op_sel_hi:[1,0]
    v_cvt_pk_f16_f32 v253, v46, v47
    ds_write_addtid_b32 v253 offset:576
    v_pk_mul_f16 v252, v253, v63 op_sel_hi:[1,0]
    v_pk_fma_f16 v252, v253, v63, v252 op_sel:[1,1,0] op_sel_hi:[0,1,1] neg_lo:[0,1,0]
    v_pk_fma_f32 v[254:255], v[46:47], v[46:47], v[254:255] op_sel:[1,1,0] op_sel_hi:[0,1,1] neg_lo:[0,1,0]
    ds_write_addtid_b32 v252 offset:864
    v_pk_mul_f32 v[94:95], v[254:255], v[254:255] op_sel_hi:[1,0]
    v_cvt_pk_f16_f32 v89, v254, v255
    v_pk_mul_f16 v88, v89, v63 op_sel_hi:[1,0]
    ds_write_addtid_b32 v89 offset:2592
    v_pk_fma_f16 v88, v89, v63, v88 op_sel:[1,1,0] op_sel_hi:[0,1,1] neg_lo:[0,1,0]
    v_pk_fma_f32 v[94:95], v[254:255], v[254:255], v[94:95] op_sel:[1,1,0] op_sel_hi:[0,1,1] neg_lo:[0,1,0]
    v_pk_mul_f32 v[50:51], v[94:95], v[94:95] op_sel_hi:[1,0]
    ds_write_addtid_b32 v88 offset:2304
    v_pk_mul_f16 v252, v89, v253 op_sel_hi:[1,0]
    v_pk_fma_f16 v252, v89, v253, v252 op_sel:[1,1,0] op_sel_hi:[0,1,1] neg_lo:[0,1,0]
    v_cvt_pk_f16_f32 v56, v94, v95
    ds_write_addtid_b32 v252 offset:2880
    v_pk_fma_f32 v[50:51], v[94:95], v[94:95], v[50:51] op_sel:[1,1,0] op_sel_hi:[0,1,1] neg_lo:[0,1,0]
    v_pk_mul_f32 v[254:255], v[50:51], v[50:51] op_sel_hi:[1,0]
    v_pk_mul_f16 v88, v252, v63 op_sel_hi:[1,0]
    ds_write_addtid_b32 v56 offset:4608
    v_pk_fma_f16 v88, v252, v63, v88 op_sel:[1,1,0] op_sel_hi:[0,1,1] neg_lo:[0,1,0]
    v_pk_fma_f32 v[254:255], v[50:51], v[50:51], v[254:255] op_sel:[1,1,0] op_sel_hi:[0,1,1] neg_lo:[0,1,0]
    v_pk_mul_f32 v[46:47], v[254:255], v[254:255] op_sel_hi:[1,0]
    ds_write_addtid_b32 v88 offset:3168
    v_cvt_pk_f16_f32 v95, v254, v255
    v_pk_fma_f32 v[46:47], v[254:255], v[254:255], v[46:47] op_sel:[1,1,0] op_sel_hi:[0,1,1] neg_lo:[0,1,0]
    v_pk_mul_f32 v[250:251], v[46:47], v[46:47] op_sel_hi:[1,0]
    v_pk_fma_f32 v[250:251], v[46:47], v[46:47], v[250:251] op_sel:[1,1,0] op_sel_hi:[0,1,1] neg_lo:[0,1,0]
    v_pk_mul_f32 v[248:249], v[250:251], v[250:251] op_sel_hi:[1,0]
    v_cvt_pk_f16_f32 v94, v250, v251
    ds_write_addtid_b32 v94 offset:2016
    v_pk_fma_f32 v[248:249], v[250:251], v[250:251], v[248:249] op_sel:[1,1,0] op_sel_hi:[0,1,1] neg_lo:[0,1,0]
    v_pk_mul_f32 v[254:255], v[248:249], v[248:249] op_sel_hi:[1,0]
    v_and_b32 v51, s58, v57
    ds_read_b128 v[84:87], v31 offset:2016
    v_cvt_pk_f16_f32 v88, v248, v249
    v_pk_mul_f16 v63, v56, v88 op_sel_hi:[1,0]
    v_pk_fma_f16 v63, v56, v88, v63 op_sel:[1,1,0] op_sel_hi:[0,1,1] neg_lo:[0,1,0]
    ds_write_addtid_b32 v63 offset:3456
    v_and_b32 v50, s58, v48
    v_mul_f32 v51, v51, v93
    v_pk_fma_f32 v[254:255], v[248:249], v[248:249], v[254:255] op_sel:[1,1,0] op_sel_hi:[0,1,1] neg_lo:[0,1,0]
    ds_read_b128 v[96:99], v31 offset:2080
    v_mul_f32 v50, v50, v92
    v_cvt_pk_f16_f32 v94, v254, v255
    v_fract_f32 v47, v51
    ds_write_addtid_b32 v88 offset:1152
    v_pk_mul_f16 v93, v89, v88 op_sel_hi:[1,0]
    v_pk_fma_f16 v93, v89, v88, v93 op_sel:[1,1,0] op_sel_hi:[0,1,1] neg_lo:[0,1,0]
    v_pk_mul_f16 v57, v63, v56 op_sel_hi:[1,0]
    ds_read_b128 v[100:103], v31 offset:2144
    v_pk_fma_f16 v57, v63, v56, v57 op_sel:[1,1,0] op_sel_hi:[0,1,1] neg_lo:[0,1,0]
    v_exp_f32 v46, v50
    ds_write_addtid_b32 v93 offset:4320
    v_pk_mul_f16 v255, v93, v56 op_sel_hi:[1,0]
    v_pk_fma_f16 v255, v93, v56, v255 op_sel:[1,1,0] op_sel_hi:[0,1,1] neg_lo:[0,1,0]
    v_pk_mul_f16 v254, v57, v88 op_sel_hi:[1,0]
    ds_read_b128 v[104:107], v31 offset:2208
    v_pk_fma_f16 v254, v57, v88, v254 op_sel:[1,1,0] op_sel_hi:[0,1,1] neg_lo:[0,1,0]
    v_cos_f32 v50, v47
    ds_write_addtid_b32 v57 offset:3744
    v_pk_mul_f16 v92, v57, v94 op_sel_hi:[1,0]
    v_pk_fma_f16 v92, v57, v94, v92 op_sel:[1,1,0] op_sel_hi:[0,1,1] neg_lo:[0,1,0]
    v_pk_mul_f16 v93, v255, v88 op_sel_hi:[1,0]
    ds_write_addtid_b32 v255 offset:4032
    v_pk_fma_f16 v93, v255, v88, v93 op_sel:[1,1,0] op_sel_hi:[0,1,1] neg_lo:[0,1,0]
    v_sin_f32 v51, v47
    ds_write_addtid_b32 v254 offset:5472
    v_pk_mul_f16 v89, v254, v94 op_sel_hi:[1,0]
    v_pk_fma_f16 v89, v254, v94, v89 op_sel:[1,1,0] op_sel_hi:[0,1,1] neg_lo:[0,1,0]
    v_pk_mul_f32 v[50:51], v[50:51], v[46:47] op_sel_hi:[1,0]
    ds_write_addtid_b32 v92 offset:6336
    v_pk_mul_f16 v63, v255, v94 op_sel_hi:[1,0]
    v_pk_fma_f16 v63, v255, v94, v63 op_sel:[1,1,0] op_sel_hi:[0,1,1] neg_lo:[0,1,0]
    v_pk_mul_f32 v[250:251], v[50:51], v[50:51] op_sel_hi:[1,0]
    s_waitcnt vmcnt(2)
    ds_write_addtid_b32 v93 offset:5184
    v_pk_mul_f16 v254, v253, v88 op_sel_hi:[1,0]
    v_pk_fma_f16 v254, v253, v88, v254 op_sel:[1,1,0] op_sel_hi:[0,1,1] neg_lo:[0,1,0]
    v_lshlrev_b32 v249, 16, v67
    ds_write_addtid_b32 v89 offset:6912
    v_lshlrev_b32 v248, 16, v66
    v_lshlrev_b32 v46, 16, v64
    v_lshlrev_b32 v47, 16, v65
    ds_write_addtid_b32 v63 offset:6048
    v_and_b32 v93, s58, v67
    v_and_b32 v92, s58, v66
    v_and_b32 v246, s58, v64
    ds_write_addtid_b32 v254 offset:1728
    v_and_b32 v247, s58, v65
    v_pk_mul_f32 v[244:245], v[46:47], v[248:249] op_sel_hi:[1,0]
    v_pk_mul_f32 v[242:243], v[246:247], v[92:93] op_sel_hi:[1,0]
    ds_read_b128 v[108:111], v30 offset:2592
    v_pk_fma_f32 v[244:245], v[46:47], v[248:249], v[244:245] op_sel:[1,1,0] op_sel_hi:[0,1,1] neg_lo:[0,1,0]
    v_pk_fma_f32 v[242:243], v[246:247], v[92:93], v[242:243] op_sel:[1,1,0] op_sel_hi:[0,1,1] neg_lo:[0,1,0]
    v_max3_f32 v255, abs(v244), abs(v245), abs(v242)
    ds_read_b128 v[64:67], v30 offset:2656
    v_pk_mul_f16 v254, v252, v88 op_sel_hi:[1,0]
    v_pk_fma_f16 v254, v252, v88, v254 op_sel:[1,1,0] op_sel_hi:[0,1,1] neg_lo:[0,1,0]
    v_max_f32_e64 v255, v255, abs(v243)
    ds_write_addtid_b32 v254 offset:1440
    v_cvt_pk_f16_f32 v253, v50, v51
    v_max_u32_dpp v255, v255, v255 row_shr:1 row_mask:0xf bank_mask:0xf
    v_pk_fma_f32 v[250:251], v[50:51], v[50:51], v[250:251] op_sel:[1,1,0] op_sel_hi:[0,1,1] neg_lo:[0,1,0]
    s_mov_b32 m0, s52
    ds_read_b128 v[112:115], v30 offset:2720
    v_max_u32_dpp v255, v255, v255 row_shr:2 row_mask:0xf bank_mask:0xf
    v_pk_mul_f32 v[248:249], v[250:251], v[250:251] op_sel_hi:[1,0]
    v_cvt_pk_f16_f32 v254, v250, v251
    ds_read_b128 v[116:119], v30 offset:2784
    v_max_u32_dpp v255, v255, v255 row_shr:4 row_mask:0xf bank_mask:0xf
    v_pk_fma_f32 v[248:249], v[250:251], v[250:251], v[248:249] op_sel:[1,1,0] op_sel_hi:[0,1,1] neg_lo:[0,1,0]
    v_pk_mul_f32 v[246:247], v[248:249], v[248:249] op_sel_hi:[1,0]
    ds_read_b128 v[120:123], v29 offset:0
    v_max_u32_dpp v255, v255, v255 row_shr:8 row_mask:0xf bank_mask:0xf
    v_cvt_pk_f16_f32 v252, v248, v249
    v_pk_fma_f32 v[246:247], v[248:249], v[248:249], v[246:247] op_sel:[1,1,0] op_sel_hi:[0,1,1] neg_lo:[0,1,0]
    ds_read_b128 v[124:127], v29 offset:64
    v_max_u32_dpp v255, v255, v255 row_bcast:15 row_mask:0xa bank_mask:0xf
    v_pk_mul_f32 v[240:241], v[246:247], v[246:247] op_sel_hi:[1,0]
    v_cvt_pk_f16_f32 v94, v246, v247
    ds_read_b128 v[128:131], v29 offset:128
    v_max_u32_dpp v255, v255, v255 row_bcast:31 row_mask:0xc bank_mask:0xf
    v_pk_fma_f32 v[240:241], v[246:247], v[246:247], v[240:241] op_sel:[1,1,0] op_sel_hi:[0,1,1] neg_lo:[0,1,0]
    v_readlane_b32 s46, v255, 63
    s_nop 0
    s_and_b32 s46, s46, 0x7f800000
    s_sub_u32 s48, 0x7f000000, s46
    ds_read_b128 v[132:135], v29 offset:192
    v_pk_mul_f32 v[244:245], v[244:245], s[48:49] op_sel_hi:[1,0]
    v_pk_mul_f32 v[242:243], v[242:243], s[48:49] op_sel_hi:[1,0]
    v_cvt_pk_f16_f32 v247, v244, -v245
    ds_write_addtid_b32 v247 offset:61200
    v_pk_mul_f16 v255, v247, v56 op_sel_hi:[1,0]
    v_pk_fma_f16 v255, v247, v56, v255 op_sel:[1,1,0] op_sel_hi:[0,1,1] neg_hi:[0,1,0]
    v_pk_mul_f16 v246, v247, v95 op_sel_hi:[1,0]
    ds_write_addtid_b32 v255 offset:61488
    v_pk_fma_f16 v246, v247, v95, v246 op_sel:[1,1,0] op_sel_hi:[0,1,1] neg_hi:[0,1,0]
    v_pk_mul_f16 v245, v255, v56 op_sel_hi:[1,0]
    v_pk_fma_f16 v245, v255, v56, v245 op_sel:[1,1,0] op_sel_hi:[0,1,1] neg_hi:[0,1,0]
    ds_write_addtid_b32 v246 offset:62352
    v_pk_mul_f16 v244, v255, v95 op_sel_hi:[1,0]
    v_pk_fma_f16 v244, v255, v95, v244 op_sel:[1,1,0] op_sel_hi:[0,1,1] neg_hi:[0,1,0]
    v_cvt_pk_f16_f32 v93, v242, -v243
    ds_write_addtid_b32 v245 offset:61776
    v_pk_mul_f16 v247, v246, v95 op_sel_hi:[1,0]
    v_pk_fma_f16 v247, v246, v95, v247 op_sel:[1,1,0] op_sel_hi:[0,1,1] neg_hi:[0,1,0]
    v_pk_mul_f16 v92, v245, v56 op_sel_hi:[1,0]
    ds_write_addtid_b32 v244 offset:62640
    v_pk_fma_f16 v92, v245, v56, v92 op_sel:[1,1,0] op_sel_hi:[0,1,1] neg_hi:[0,1,0]
    v_pk_mul_f16 v255, v245, v95 op_sel_hi:[1,0]
    v_pk_fma_f16 v255, v245, v95, v255 op_sel:[1,1,0] op_sel_hi:[0,1,1] neg_hi:[0,1,0]
    ds_write_addtid_b32 v247 offset:63504
    v_pk_mul_f16 v246, v244, v95 op_sel_hi:[1,0]
    v_pk_fma_f16 v246, v244, v95, v246 op_sel:[1,1,0] op_sel_hi:[0,1,1] neg_hi:[0,1,0]
    v_pk_mul_f32 v[242:243], v[240:241], v[240:241] op_sel_hi:[1,0]
    ds_write_addtid_b32 v92 offset:62064
    v_pk_mul_f16 v89, v247, v95 op_sel_hi:[1,0]
    v_pk_fma_f16 v89, v247, v95, v89 op_sel:[1,1,0] op_sel_hi:[0,1,1] neg_hi:[0,1,0]
    v_pk_fma_f32 v[242:243], v[240:241], v[240:241], v[242:243] op_sel:[1,1,0] op_sel_hi:[0,1,1] neg_lo:[0,1,0]
    ds_write_addtid_b32 v255 offset:62928
    v_pk_mul_f16 v245, v92, v95 op_sel_hi:[1,0]
    v_pk_fma_f16 v245, v92, v95, v245 op_sel:[1,1,0] op_sel_hi:[0,1,1] neg_hi:[0,1,0]
    v_pk_mul_f32 v[56:57], v[242:243], v[242:243] op_sel_hi:[1,0]
    ds_write_addtid_b32 v246 offset:63792
    v_pk_mul_f16 v247, v255, v95 op_sel_hi:[1,0]
    v_cvt_pk_f16_f32 v244, v242, v243
    v_pk_fma_f16 v247, v255, v95, v247 op_sel:[1,1,0] op_sel_hi:[0,1,1] neg_hi:[0,1,0]
    ds_write_addtid_b32 v89 offset:64656
    v_pk_fma_f32 v[56:57], v[242:243], v[242:243], v[56:57] op_sel:[1,1,0] op_sel_hi:[0,1,1] neg_lo:[0,1,0]
    v_pk_mul_f16 v92, v246, v95 op_sel_hi:[1,0]
    v_pk_fma_f16 v92, v246, v95, v92 op_sel:[1,1,0] op_sel_hi:[0,1,1] neg_hi:[0,1,0]
    ds_write_addtid_b32 v245 offset:63216
    v_pk_mul_f32 v[50:51], v[56:57], v[56:57] op_sel_hi:[1,0]
    v_pk_mul_f16 v255, v245, v95 op_sel_hi:[1,0]
    v_pk_fma_f16 v255, v245, v95, v255 op_sel:[1,1,0] op_sel_hi:[0,1,1] neg_hi:[0,1,0]
    ds_write_addtid_b32 v247 offset:64080
    v_pk_fma_f32 v[50:51], v[56:57], v[56:57], v[50:51] op_sel:[1,1,0] op_sel_hi:[0,1,1] neg_lo:[0,1,0]
    v_pk_mul_f32 v[88:89], v[50:51], v[50:51] op_sel_hi:[1,0]
    v_pk_mul_f16 v246, v247, v95 op_sel_hi:[1,0]
    ds_write_addtid_b32 v92 offset:64944
    v_pk_fma_f16 v246, v247, v95, v246 op_sel:[1,1,0] op_sel_hi:[0,1,1] neg_hi:[0,1,0]
    v_cvt_pk_f16_f32 v245, v50, v51
    v_pk_mul_f16 v63, v255, v95 op_sel_hi:[1,0]
    ds_write_addtid_b32 v255 offset:64368
    v_pk_fma_f16 v63, v255, v95, v63 op_sel:[1,1,0] op_sel_hi:[0,1,1] neg_hi:[0,1,0]
    v_pk_fma_f32 v[88:89], v[50:51], v[50:51], v[88:89] op_sel:[1,1,0] op_sel_hi:[0,1,1] neg_lo:[0,1,0]
    v_pk_mul_f32 v[56:57], v[88:89], v[88:89] op_sel_hi:[1,0]
    ds_write_addtid_b32 v246 offset:65232
    v_pk_mul_f16 v247, v93, v94 op_sel_hi:[1,0]
    v_pk_fma_f16 v247, v93, v94, v247 op_sel:[1,1,0] op_sel_hi:[0,1,1] neg_hi:[0,1,0]
    v_pk_mul_f16 v92, v93, v244 op_sel_hi:[1,0]
    ds_write_addtid_b32 v63 offset:65520
    v_cvt_pk_f16_f32 v255, v88, v89
    v_pk_fma_f32 v[56:57], v[88:89], v[88:89], v[56:57] op_sel:[1,1,0] op_sel_hi:[0,1,1] neg_lo:[0,1,0]
    v_cvt_pk_f16_f32 v246, v56, v57
    s_mov_b32 m0, s52
    s_setprio 2
    ds_read_b128 v[136:139], v28 offset:0
    v_mul_f32 v90, s46, v90
    v_mul_f32 v91, 0x43000000, v90
    v_cndmask_b32 v88, 0, v91, s[66:67]
    ds_read_b128 v[140:143], v28 offset:64
    v_pk_fma_f16 v92, v93, v244, v92 op_sel:[1,1,0] op_sel_hi:[0,1,1] neg_hi:[0,1,0]
    v_pk_mul_f16 v95, v247, v94 op_sel_hi:[1,0]
    v_pk_fma_f16 v95, v247, v94, v95 op_sel:[1,1,0] op_sel_hi:[0,1,1] neg_hi:[0,1,0]
    ds_read_b128 v[144:147], v28 offset:128
    v_pk_mul_f16 v63, v247, v244 op_sel_hi:[1,0]
    v_pk_fma_f16 v63, v247, v244, v63 op_sel:[1,1,0] op_sel_hi:[0,1,1] neg_hi:[0,1,0]
    v_pk_mul_f16 v57, v92, v244 op_sel_hi:[1,0]
    s_waitcnt lgkmcnt(2)
    ds_read_b128 v[148:151], v28 offset:192
    v_pk_mul_f16 v56, v136, v84 op_sel_hi:[1,0]
    v_pk_mul_f16 v54, v137, v85 op_sel_hi:[1,0]
    v_pk_fma_f16 v84, v136, v84, v56 op_sel:[1,1,0] op_sel_hi:[0,1,1] neg_hi:[0,1,0]
    ds_write_addtid_b32 v93 offset:61200
    v_pk_fma_f16 v85, v137, v85, v54 op_sel:[1,1,0] op_sel_hi:[0,1,1] neg_hi:[0,1,0]
    v_pk_mul_f16 v51, v138, v86 op_sel_hi:[1,0]
    v_pk_mul_f16 v50, v139, v87 op_sel_hi:[1,0]
    s_waitcnt lgkmcnt(2)
    ds_write_addtid_b32 v247 offset:61488
    v_pk_fma_f16 v86, v138, v86, v51 op_sel:[1,1,0] op_sel_hi:[0,1,1] neg_hi:[0,1,0]
    v_pk_fma_f16 v87, v139, v87, v50 op_sel:[1,1,0] op_sel_hi:[0,1,1] neg_hi:[0,1,0]
    v_pk_mul_f16 v93, v140, v96 op_sel_hi:[1,0]
    ds_write_addtid_b32 v92 offset:62352
    v_pk_fma_f16 v57, v92, v244, v57 op_sel:[1,1,0] op_sel_hi:[0,1,1] neg_hi:[0,1,0]
    v_pk_mul_f16 v56, v141, v97 op_sel_hi:[1,0]
    v_pk_fma_f16 v96, v140, v96, v93 op_sel:[1,1,0] op_sel_hi:[0,1,1] neg_hi:[0,1,0]
    ds_write_addtid_b32 v95 offset:61776
    v_pk_mul_f16 v247, v95, v94 op_sel_hi:[1,0]
    v_pk_fma_f16 v247, v95, v94, v247 op_sel:[1,1,0] op_sel_hi:[0,1,1] neg_hi:[0,1,0]
    v_pk_fma_f16 v97, v141, v97, v56 op_sel:[1,1,0] op_sel_hi:[0,1,1] neg_hi:[0,1,0]
    ds_write_addtid_b32 v63 offset:62640
    v_pk_mul_f16 v92, v95, v244 op_sel_hi:[1,0]
    v_pk_fma_f16 v92, v95, v244, v92 op_sel:[1,1,0] op_sel_hi:[0,1,1] neg_hi:[0,1,0]
    v_pk_mul_f16 v93, v142, v98 op_sel_hi:[1,0]
    ds_write_addtid_b32 v57 offset:63504
    v_pk_mul_f16 v54, v63, v244 op_sel_hi:[1,0]
    v_pk_fma_f16 v54, v63, v244, v54 op_sel:[1,1,0] op_sel_hi:[0,1,1] neg_hi:[0,1,0]
    v_pk_mul_f16 v56, v143, v99 op_sel_hi:[1,0]
    ds_write_addtid_b32 v247 offset:62064
    v_pk_mul_f16 v95, v57, v244 op_sel_hi:[1,0]
    v_pk_fma_f16 v95, v57, v244, v95 op_sel:[1,1,0] op_sel_hi:[0,1,1] neg_hi:[0,1,0]
    v_pk_fma_f16 v98, v142, v98, v93 op_sel:[1,1,0] op_sel_hi:[0,1,1] neg_hi:[0,1,0]
    ds_write_addtid_b32 v92 offset:62928
    v_pk_mul_f16 v63, v247, v244 op_sel_hi:[1,0]
    v_pk_fma_f16 v63, v247, v244, v63 op_sel:[1,1,0] op_sel_hi:[0,1,1] neg_hi:[0,1,0]
    v_pk_fma_f16 v99, v143, v99, v56 op_sel:[1,1,0] op_sel_hi:[0,1,1] neg_hi:[0,1,0]
    ds_write_addtid_b32 v54 offset:63792
    v_pk_mul_f16 v57, v92, v244 op_sel_hi:[1,0]
    v_pk_fma_f16 v57, v92, v244, v57 op_sel:[1,1,0] op_sel_hi:[0,1,1] neg_hi:[0,1,0]
    v_pk_mul_f16 v93, v144, v100 op_sel_hi:[1,0]
    ds_write_addtid_b32 v95 offset:64656
    v_pk_mul_f16 v247, v145, v101 op_sel_hi:[1,0]
    v_pk_fma_f16 v100, v144, v100, v93 op_sel:[1,1,0] op_sel_hi:[0,1,1] neg_hi:[0,1,0]
    v_pk_mul_f16 v56, v54, v244 op_sel_hi:[1,0]
    ds_write_addtid_b32 v63 offset:63216
    v_pk_fma_f16 v56, v54, v244, v56 op_sel:[1,1,0] op_sel_hi:[0,1,1] neg_hi:[0,1,0]
    v_pk_fma_f16 v101, v145, v101, v247 op_sel:[1,1,0] op_sel_hi:[0,1,1] neg_hi:[0,1,0]
    v_pk_mul_f16 v95, v146, v102 op_sel_hi:[1,0]
    ds_write_addtid_b32 v57 offset:64080
    v_pk_mul_f16 v93, v63, v244 op_sel_hi:[1,0]
    v_pk_fma_f16 v93, v63, v244, v93 op_sel:[1,1,0] op_sel_hi:[0,1,1] neg_hi:[0,1,0]
    v_pk_mul_f16 v92, v147, v103 op_sel_hi:[1,0]
    ds_write_addtid_b32 v56 offset:64944
    v_pk_mul_f16 v247, v57, v244 op_sel_hi:[1,0]
    v_pk_fma_f16 v247, v57, v244, v247 op_sel:[1,1,0] op_sel_hi:[0,1,1] neg_hi:[0,1,0]
    v_pk_fma_f16 v102, v146, v102, v95 op_sel:[1,1,0] op_sel_hi:[0,1,1] neg_hi:[0,1,0]
    ds_write_addtid_b32 v93 offset:64368
    v_pk_mul_f16 v63, v93, v244 op_sel_hi:[1,0]
    v_pk_fma_f16 v63, v93, v244, v63 op_sel:[1,1,0] op_sel_hi:[0,1,1] neg_hi:[0,1,0]
    v_pk_fma_f16 v103, v147, v103, v92 op_sel:[1,1,0] op_sel_hi:[0,1,1] neg_hi:[0,1,0]
    ds_write_addtid_b32 v247 offset:65232
    v_pk_mul_f16 v57, v94, v255 op_sel_hi:[1,0]
    v_pk_fma_f16 v57, v94, v255, v57 op_sel:[1,1,0] op_sel_hi:[0,1,1] neg_lo:[0,1,0]
    v_pk_mul_f16 v95, v252, v255 op_sel_hi:[1,0]
    s_waitcnt lgkmcnt(2)
    ds_write_addtid_b32 v63 offset:65520
    v_pk_mul_f16 v244, v148, v104 op_sel_hi:[1,0]
    v_pk_mul_f16 v93, v149, v105 op_sel_hi:[1,0]
    v_pk_fma_f16 v104, v148, v104, v244 op_sel:[1,1,0] op_sel_hi:[0,1,1] neg_hi:[0,1,0]
    s_mov_b32 m0, s51
    ds_read_b128 v[152:155], v28 offset:0
    v_mfma_f32_16x16x32_f16 v[156:159], v[108:111], v[136:139], 0
    v_pk_fma_f16 v105, v149, v105, v93 op_sel:[1,1,0] op_sel_hi:[0,1,1] neg_hi:[0,1,0]
    ds_write_addtid_b32 v245 offset:2016
    v_pk_mul_f16 v247, v150, v106 op_sel_hi:[1,0]
    v_pk_mul_f16 v244, v151, v107 op_sel_hi:[1,0]
    v_pk_fma_f16 v106, v150, v106, v247 op_sel:[1,1,0] op_sel_hi:[0,1,1] neg_hi:[0,1,0]
    ds_read_b128 v[160:163], v31 offset:2016
    v_mfma_f32_16x16x32_f16 v[156:159], v[64:67], v[140:143], v[156:159]
    v_pk_fma_f16 v107, v151, v107, v244 op_sel:[1,1,0] op_sel_hi:[0,1,1] neg_hi:[0,1,0]
    ds_write_addtid_b32 v57 offset:3456
    v_pk_fma_f16 v95, v252, v255, v95 op_sel:[1,1,0] op_sel_hi:[0,1,1] neg_lo:[0,1,0]
    v_pk_mul_f16 v245, v57, v94 op_sel_hi:[1,0]
    v_pk_fma_f16 v245, v57, v94, v245 op_sel:[1,1,0] op_sel_hi:[0,1,1] neg_lo:[0,1,0]
    ds_read_b128 v[164:167], v28 offset:64
    v_mfma_f32_16x16x32_f16 v[156:159], v[112:115], v[144:147], v[156:159]
    v_pk_mul_f16 v247, v95, v94 op_sel_hi:[1,0]
    s_waitcnt lgkmcnt(2)
    ds_write_addtid_b32 v95 offset:4320
    v_pk_mul_f16 v244, v152, v160 op_sel_hi:[1,0]
    v_pk_mul_f16 v93, v153, v161 op_sel_hi:[1,0]
    v_pk_fma_f16 v160, v152, v160, v244 op_sel:[1,1,0] op_sel_hi:[0,1,1] neg_hi:[0,1,0]
    ds_read_b128 v[168:171], v31 offset:2080
    v_mfma_f32_16x16x32_f16 v[156:159], v[116:119], v[148:151], v[156:159]
    v_pk_fma_f16 v161, v153, v161, v93 op_sel:[1,1,0] op_sel_hi:[0,1,1] neg_hi:[0,1,0]
    ds_write_addtid_b32 v252 offset:2592
    v_pk_mul_f16 v92, v154, v162 op_sel_hi:[1,0]
    v_pk_mul_f16 v63, v155, v163 op_sel_hi:[1,0]
    v_pk_fma_f16 v162, v154, v162, v92 op_sel:[1,1,0] op_sel_hi:[0,1,1] neg_hi:[0,1,0]
    ds_read_b128 v[172:175], v28 offset:128
    v_mfma_f32_16x16x32_f16 v[176:179], v[108:111], v[84:87], 0
    v_pk_fma_f16 v163, v155, v163, v63 op_sel:[1,1,0] op_sel_hi:[0,1,1] neg_hi:[0,1,0]
    ds_write_addtid_b32 v245 offset:3744
    v_pk_fma_f16 v247, v95, v94, v247 op_sel:[1,1,0] op_sel_hi:[0,1,1] neg_lo:[0,1,0]
    v_pk_mul_f16 v244, v245, v255 op_sel_hi:[1,0]
    v_pk_fma_f16 v244, v245, v255, v244 op_sel:[1,1,0] op_sel_hi:[0,1,1] neg_lo:[0,1,0]
    s_waitcnt lgkmcnt(2)
    ds_read_b128 v[180:183], v31 offset:2144
    v_mfma_f32_16x16x32_f16 v[176:179], v[64:67], v[96:99], v[176:179]
    v_pk_mul_f16 v93, v164, v168 op_sel_hi:[1,0]
    ds_write_addtid_b32 v247 offset:4032
    v_pk_mul_f16 v95, v245, v246 op_sel_hi:[1,0]
    v_pk_fma_f16 v95, v245, v246, v95 op_sel:[1,1,0] op_sel_hi:[0,1,1] neg_lo:[0,1,0]
    v_pk_mul_f16 v92, v247, v255 op_sel_hi:[1,0]
    ds_read_b128 v[108:111], v28 offset:192
    v_mfma_f32_16x16x32_f16 v[176:179], v[112:115], v[100:103], v[176:179]
    v_pk_mul_f16 v63, v165, v169 op_sel_hi:[1,0]
    ds_write_addtid_b32 v94 offset:4608
    v_pk_fma_f16 v92, v247, v255, v92 op_sel:[1,1,0] op_sel_hi:[0,1,1] neg_lo:[0,1,0]
    v_pk_mul_f16 v245, v244, v246 op_sel_hi:[1,0]
    v_pk_fma_f16 v245, v244, v246, v245 op_sel:[1,1,0] op_sel_hi:[0,1,1] neg_lo:[0,1,0]
    ds_read_b128 v[64:67], v31 offset:2208
    v_mfma_f32_16x16x32_f16 v[176:179], v[116:119], v[104:107], v[176:179]
    v_pk_fma_f16 v168, v164, v168, v93 op_sel:[1,1,0] op_sel_hi:[0,1,1] neg_hi:[0,1,0]
    ds_write_addtid_b32 v244 offset:5472
    v_pk_mul_f16 v94, v247, v246 op_sel_hi:[1,0]
    v_pk_fma_f16 v94, v247, v246, v94 op_sel:[1,1,0] op_sel_hi:[0,1,1] neg_lo:[0,1,0]
    v_pk_mul_f16 v57, v252, v254 op_sel_hi:[1,0]
    ds_write_addtid_b32 v95 offset:6336
    v_mfma_f32_16x16x32_f16 v[112:115], v[120:123], v[136:139], 0
    v_pk_fma_f16 v169, v165, v169, v63 op_sel:[1,1,0] op_sel_hi:[0,1,1] neg_hi:[0,1,0]
    ds_write_addtid_b32 v92 offset:5184
    v_pk_mul_f16 v244, v166, v170 op_sel_hi:[1,0]
    v_pk_fma_f16 v57, v252, v254, v57 op_sel:[1,1,0] op_sel_hi:[0,1,1] neg_lo:[0,1,0]
    v_mfma_f32_16x16x32_f16 v[112:115], v[132:135], v[148:151], v[112:115]
    v_pk_mul_f16 v247, v254, v253 op_sel_hi:[1,0]
    v_pk_fma_f16 v247, v254, v253, v247 op_sel:[1,1,0] op_sel_hi:[0,1,1] neg_lo:[0,1,0]
    ds_write_addtid_b32 v94 offset:6048
    v_pk_mul_f16 v246, v252, v253 op_sel_hi:[1,0]
    v_pk_fma_f16 v246, v252, v253, v246 op_sel:[1,1,0] op_sel_hi:[0,1,1] neg_lo:[0,1,0]
    s_setprio 1
    ds_write_addtid_b32 v245 offset:6912
    ds_read_b128 v[116:119], v30 offset:2784
    v_mfma_f32_16x16x32_f16 v[136:139], v[132:135], v[104:107], 0
    ds_read_b128 v[92:95], v30 offset:2720
    s_waitcnt lgkmcnt(4)
    v_pk_mul_f16 v63, v175, v183 op_sel_hi:[1,0]
    v_mfma_f32_16x16x32_f16 v[112:115], v[128:131], v[144:147], v[112:115]
    v_pk_mul_f16 v252, v167, v171 op_sel_hi:[1,0]
    v_pk_mul_f16 v245, v173, v181 op_sel_hi:[1,0]
    v_mfma_f32_16x16x32_f16 v[136:139], v[120:123], v[84:87], v[136:139]
    ds_write_addtid_b32 v57 offset:2880
    ds_read_b128 v[104:107], v30 offset:2656
    v_mfma_f32_16x16x32_f16 v[136:139], v[124:127], v[96:99], v[136:139]
    v_pk_mul_f16 v56, v57, v255 op_sel_hi:[1,0]
    v_pk_mul_f16 v54, v109, v65 op_sel_hi:[1,0]
    ds_read_b128 v[132:135], v30 offset:2592
    v_pk_mul_f16 v51, v172, v180 op_sel_hi:[1,0]
    v_pk_fma_f16 v180, v172, v180, v51 op_sel:[1,1,0] op_sel_hi:[0,1,1] neg_hi:[0,1,0]
    v_mfma_f32_16x16x32_f16 v[112:115], v[124:127], v[140:143], v[112:115]
    ds_write_addtid_b32 v253 offset:288
    ds_write_addtid_b32 v247 offset:864
    ds_write_addtid_b32 v254 offset:576
    v_pk_mul_f16 v50, v111, v67 op_sel_hi:[1,0]
    v_pk_fma_f16 v170, v166, v170, v244 op_sel:[1,1,0] op_sel_hi:[0,1,1] neg_hi:[0,1,0]
    v_pk_fma_f16 v56, v57, v255, v56 op_sel:[1,1,0] op_sel_hi:[0,1,1] neg_lo:[0,1,0]
    v_mfma_f32_16x16x32_f16 v[136:139], v[128:131], v[100:103], v[136:139]
    v_pk_fma_f16 v183, v175, v183, v63 op_sel:[1,1,0] op_sel_hi:[0,1,1] neg_hi:[0,1,0]
    ds_write_addtid_b32 v246 offset:2304
    v_pk_mul_f16 v247, v254, v255 op_sel_hi:[1,0]
    v_pk_mul_f16 v51, v57, v253 op_sel_hi:[1,0]
    v_pk_fma_f16 v181, v173, v181, v245 op_sel:[1,1,0] op_sel_hi:[0,1,1] neg_hi:[0,1,0]
    v_pk_fma_f16 v51, v57, v253, v51 op_sel:[1,1,0] op_sel_hi:[0,1,1] neg_lo:[0,1,0]
    v_pk_fma_f16 v247, v254, v255, v247 op_sel:[1,1,0] op_sel_hi:[0,1,1] neg_lo:[0,1,0]
    s_waitcnt lgkmcnt(1)
    ds_write_addtid_b32 v247 offset:1728
    v_mfma_f32_16x16x32_f16 v[156:159], v[132:135], v[152:155], v[156:159]
    v_pk_mul_f16 v63, v174, v182 op_sel_hi:[1,0]
    v_pk_fma_f16 v182, v174, v182, v63 op_sel:[1,1,0] op_sel_hi:[0,1,1] neg_hi:[0,1,0]
    v_pk_mul_f16 v48, v108, v64 op_sel_hi:[1,0]
    v_pk_fma_f16 v171, v167, v171, v252 op_sel:[1,1,0] op_sel_hi:[0,1,1] neg_hi:[0,1,0]
    ds_write_addtid_b32 v56 offset:1440
    ds_write_addtid_b32 v51 offset:3168
    v_mfma_f32_16x16x32_f16 v[176:179], v[132:135], v[160:163], v[176:179]
    ds_write_addtid_b32 v255 offset:1152
    v_pk_fma_f16 v65, v109, v65, v54 op_sel:[1,1,0] op_sel_hi:[0,1,1] neg_hi:[0,1,0]
    v_mfma_f32_16x16x32_f16 v[156:159], v[104:107], v[164:167], v[156:159]
    ds_read_b128 v[84:87], v29 offset:64
    s_mov_b32 m0, s50
    buffer_load_dwordx4 v[76:79], v49, s[36:39], s47 offen offset:0 nt
    ds_read_b128 v[96:99], v29 offset:0
    buffer_load_dwordx4 v[80:83], v49, s[36:39], s47 offen offset:2048 nt
    v_pk_fma_f16 v67, v111, v67, v50 op_sel:[1,1,0] op_sel_hi:[0,1,1] neg_hi:[0,1,0]
    v_mfma_f32_16x16x32_f16 v[156:159], v[116:119], v[108:111], v[156:159]
    s_waitcnt vmcnt(2)
    v_perm_b32 v63, v73, v69, s44
    s_setprio 0
    v_perm_b32 v57, v73, v69, s45
    v_pk_mul_f16 v56, v110, v66 op_sel_hi:[1,0]
    v_perm_b32 v54, v72, v68, s45
    v_mfma_f32_16x16x32_f16 v[176:179], v[92:95], v[180:183], v[176:179]
    ds_write_addtid_b32 v54 offset:29952
    v_pk_fma_f16 v64, v108, v64, v48 op_sel:[1,1,0] op_sel_hi:[0,1,1] neg_hi:[0,1,0]
    v_pk_fma_f16 v66, v110, v66, v56 op_sel:[1,1,0] op_sel_hi:[0,1,1] neg_hi:[0,1,0]
    v_perm_b32 v73, v74, v70, s44
    v_mfma_f32_16x16x32_f16 v[156:159], v[92:95], v[172:175], v[156:159]
    ds_write_addtid_b32 v73 offset:43776
    v_perm_b32 v69, v72, v68, s44
    v_mfma_f32_16x16x32_f16 v[176:179], v[104:107], v[168:171], v[176:179]
    ds_write_addtid_b32 v69 offset:25344
    v_perm_b32 v56, v74, v70, s45
    v_mfma_f32_16x16x32_f16 v[176:179], v[116:119], v[64:67], v[176:179]
    ds_write_addtid_b32 v63 offset:34560
    ds_read_b128 v[48:51], v29 offset:128
    v_mul_f32 v156, v156, v90
    v_mul_f32 v157, v157, v91
    v_perm_b32 v73, v75, v71, s44
    s_waitcnt lgkmcnt(3)
    v_mfma_f32_16x16x32_f16 v[112:115], v[84:87], v[164:167], v[112:115]
    ds_write_addtid_b32 v73 offset:52992
    ds_write_addtid_b32 v57 offset:39168
    v_mul_f32 v158, v158, v88
    v_mul_f32 v69, v179, v90
    v_mul_f32 v68, v178, v90
    v_mfma_f32_16x16x32_f16 v[112:115], v[96:99], v[152:155], v[112:115]
    ds_write_addtid_b32 v56 offset:48384
    v_perm_b32 v74, v75, v71, s45
    v_mul_f32 v176, v176, v90
    v_mfma_f32_16x16x32_f16 v[136:139], v[96:99], v[160:163], v[136:139]
    ds_write_addtid_b32 v74 offset:57600
    ds_read_b128 v[92:95], v29 offset:192
    v_mul_f32 v177, v177, v91
    v_mul_f32 v178, v178, v88
    v_mfma_f32_16x16x32_f16 v[136:139], v[84:87], v[168:171], v[136:139]
    ds_write_b64 v39, v[60:61] offset:8
    v_mul_f32 v179, v179, v88
    v_mul_f32 v159, v159, v88
    v_cvt_pk_bf16_f32 v71, v157, v177
    v_cvt_pk_bf16_f32 v91, v178, v179
    v_cvt_pk_bf16_f32 v70, v158, v159
    v_writelane_b32 v91, 0, 47
    s_waitcnt lgkmcnt(1)
    v_mfma_f32_16x16x32_f16 v[112:115], v[48:51], v[172:175], v[112:115]
    s_barrier
    ds_write_b16 v36, v71 offset:60
    v_cvt_pk_bf16_f32 v68, v68, v69
    v_mfma_f32_16x16x32_f16 v[136:139], v[48:51], v[180:183], v[136:139]
    ds_write_b16_d16_hi v36, v71 offset:92
    v_readlane_b32 s68, v68, 46
    v_readlane_b32 s69, v68, 47
    v_readlane_b32 s54, v68, 15
    v_mfma_f32_16x16x32_f16 v[112:115], v[92:95], v[108:111], v[112:115]
    s_setprio 3
    ds_write2_b32 v35, v70, v91 offset0:0 offset1:16
    v_mov_b32 v89, s54
    v_mfma_f32_16x16x32_f16 v[136:139], v[92:95], v[64:67], v[136:139]
    ds_read_b128 v[28:31], v1 offset:464
    v_pk_fma_f16 v42, v42, s53, v59 op_sel_hi:[1,0,1]
    s_nop 1
    v_fma_f32 v112, v112, v90, v62
    v_pk_fma_f16 v27, v19, s53, v42 op_sel:[0,1,0]
    v_readlane_b32 s53, v68, 14
    ds_read_b128 v[48:51], v1 offset:448
    v_mul_f32 v113, v113, v90
    v_mul_f32 v136, v136, v90
    v_mul_f32 v137, v137, v90
    v_mul_f32 v138, v138, v90
    ds_read_b128 v[60:63], v1 offset:32
    v_mul_f32 v139, v139, v90
    v_cvt_pk_bf16_f32 v57, v137, v136
    v_cvt_pk_bf16_f32 v56, v139, v138
    v_cvt_pk_bf16_f32 v47, v138, v137
    s_waitcnt lgkmcnt(1)
    ds_write_b64 v32, v[56:57] offset:8
    v_cvt_pk_bf16_f32 v46, v176, v139
    v_mul_f32 v114, v114, v90
    v_mul_f32 v115, v115, v90
    v_cvt_pk_bf16_f32 v255, v113, v112
    v_cvt_pk_bf16_f32 v254, v115, v114
    v_cvt_pk_bf16_f32 v253, v114, v113
    v_cvt_pk_bf16_f32 v252, v156, v115
    v_mfma_f32_16x16x32_bf16 v[64:67], v[28:31], v[8:11], 0
    s_pack_hh_b32_b16 s68, s68, s69
    ds_write2_b32 v34, v56, v57 offset0:1 offset1:2
    v_perm_b32 v68, s68, s68, v24
    v_perm_b32 v69, s68, s68, v25
    v_mfma_f32_16x16x32_bf16 v[72:75], v[28:31], v[12:15], 0
    ds_write2_b32 v33, v46, v47 offset0:1 offset1:2
    v_perm_b32 v70, s68, s68, v26
    v_perm_b32 v71, s68, s68, v27
    v_mfma_f32_16x16x32_bf16 v[84:87], v[48:51], v[8:11], 0
    v_mfma_f32_16x16x32_bf16 v[92:95], v[48:51], v[12:15], 0
    s_and_b32 s35, s32, 3
    s_lshl_b32 s35, s35, 5
    ds_write_b64 v32, v[46:47] offset:3264
    v_cvt_pk_bf16_f32 v96, v64, v72
    v_cvt_pk_bf16_f32 v98, v65, v73
    v_cvt_pk_bf16_f32 v24, v66, v74
    v_cvt_pk_bf16_f32 v26, v67, v75
    v_mfma_f32_16x16x32_bf16 v[100:103], v[28:31], v[20:23], 0
    s_add_u32 s35, s35, s51
    s_setprio 2
    ds_write_b64 v32, v[254:255] offset:264
    v_cvt_pk_bf16_f32 v97, v84, v92
    v_cvt_pk_bf16_f32 v99, v85, v93
    v_cvt_pk_bf16_f32 v25, v86, v94
    v_lshl_add_u32 v42, v43, 3, s35
    v_cvt_pk_bf16_f32 v27, v87, v95
    v_mad_u32_u24 v5, v45, 9, v42
    v_mfma_f32_16x16x32_bf16 v[20:23], v[48:51], v[16:19], 0
    s_lshl_b32 s35, s32, 16
    s_add_u32 s35, s35, s30
    ds_write2_b32 v34, v254, v255 offset0:65 offset1:66
    v_lshl_add_u32 v42, v40, 11, s35
    s_lshl_b32 s35, s32, 4
    v_lshl_add_u32 v7, v53, 25, v42
    v_and_b32 v42, 12, v0
    s_nop 0
    v_cvt_pk_bf16_f32 v16, v100, v20
    ds_write2_b32 v33, v252, v253 offset0:65 offset1:66
    v_cvt_pk_bf16_f32 v17, v101, v21
    v_cvt_pk_bf16_f32 v18, v102, v22
    v_cvt_pk_bf16_f32 v19, v103, v23
    v_mul_u32_u24 v42, 1808, v42
    v_add3_u32 v58, v55, v42, s35
    s_movk_i32 s35, 144
    ds_write_b64 v32, v[252:253] offset:3520
    v_mad_u32_u24 v6, v52, s35, v58
    v_readlane_b32 s35, v255, 0
    s_nop 0
    s_pack_hh_b32_b16 s53, s53, s35
    v_perm_b32 v89, s53, v89, v38
    ds_write_b16 v37, v89
    ds_read_b64 v[20:21], v2 offset:64
    ds_read_b64 v[22:23], v2 offset:72
    ds_read_b64 v[28:29], v2 offset:576
    ds_read_b64 v[30:31], v2 offset:584
    ds_read_b128 v[32:35], v1 offset:544
    ds_read_b128 v[40:43], v1 offset:96
    s_waitcnt lgkmcnt(4)
    v_mfma_f32_16x16x32_bf16 v[36:39], v[20:23], v[60:63], 0
    s_mul_i32 s4, s31, 2621440
    s_add_u32 s5, s4, 524288
    ds_read_b64 v[44:45], v2 offset:128
    ds_read_b64 v[46:47], v2 offset:136
    ds_read_b64 v[48:49], v2 offset:640
    s_waitcnt lgkmcnt(4)
    v_mfma_f32_16x16x32_bf16 v[52:55], v[28:31], v[60:63], 0
    s_add_u32 s6, s4, 1048576
    s_add_u32 s7, s4, 1572864
    ds_read_b64 v[50:51], v2 offset:648
    ds_read_b128 v[56:59], v1 offset:608
    v_mfma_f32_16x16x32_bf16 v[64:67], v[20:23], v[32:35], 0
    s_add_u32 s8, s4, 2097152
    ds_read_b128 v[60:63], v1 offset:160
    v_mfma_f32_16x16x32_bf16 v[36:39], v[28:31], v[32:35], v[36:39]
    ds_read_b64 v[72:73], v2 offset:192
    s_waitcnt lgkmcnt(4)
    v_mfma_f32_16x16x32_bf16 v[36:39], v[44:47], v[40:43], v[36:39]
    ds_read_b64 v[74:75], v2 offset:200
    ds_read_b64 v[84:85], v2 offset:704
    s_waitcnt lgkmcnt(4)
    v_mfma_f32_16x16x32_bf16 v[52:55], v[48:51], v[40:43], v[52:55]
    ds_read_b64 v[86:87], v2 offset:712
    ds_read_b128 v[32:35], v1 offset:672
    v_mfma_f32_16x16x32_bf16 v[64:67], v[44:47], v[56:59], v[64:67]
    ds_read_b128 v[88:91], v1 offset:224
    v_mfma_f32_16x16x32_bf16 v[36:39], v[48:51], v[56:59], v[36:39]
    ds_read_b64 v[92:93], v2 offset:256
    s_waitcnt lgkmcnt(4)
    v_mfma_f32_16x16x32_bf16 v[36:39], v[72:75], v[60:63], v[36:39]
    ds_read_b64 v[94:95], v2 offset:264
    ds_read_b64 v[40:41], v2 offset:768
    s_waitcnt lgkmcnt(4)
    v_mfma_f32_16x16x32_bf16 v[52:55], v[84:87], v[60:63], v[52:55]
    s_setprio 1
    ds_read_b64 v[42:43], v2 offset:776
    ds_read_b128 v[56:59], v1 offset:736
    v_mfma_f32_16x16x32_bf16 v[64:67], v[72:75], v[32:35], v[64:67]
    ds_read_b128 v[100:103], v1 offset:288
    v_mfma_f32_16x16x32_bf16 v[36:39], v[84:87], v[32:35], v[36:39]
    ds_read_b64 v[60:61], v2 offset:320
    s_waitcnt lgkmcnt(4)
    v_mfma_f32_16x16x32_bf16 v[36:39], v[92:95], v[88:91], v[36:39]
    ds_read_b64 v[62:63], v2 offset:328
    ds_read_b64 v[104:105], v2 offset:832
    s_waitcnt lgkmcnt(4)
    v_mfma_f32_16x16x32_bf16 v[52:55], v[40:43], v[88:91], v[52:55]
    ds_read_b64 v[106:107], v2 offset:840
    ds_read_b128 v[32:35], v1 offset:800
    v_mfma_f32_16x16x32_bf16 v[64:67], v[92:95], v[56:59], v[64:67]
    ds_read_b128 v[108:111], v1 offset:352
    v_mfma_f32_16x16x32_bf16 v[36:39], v[40:43], v[56:59], v[36:39]
    ds_read_b64 v[112:113], v2 offset:384
    s_waitcnt lgkmcnt(4)
    v_mfma_f32_16x16x32_bf16 v[36:39], v[60:63], v[100:103], v[36:39]
    ds_read_b64 v[114:115], v2 offset:392
    ds_read_b64 v[88:89], v2 offset:896
    s_waitcnt lgkmcnt(4)
    v_mfma_f32_16x16x32_bf16 v[52:55], v[104:107], v[100:103], v[52:55]
    ds_read_b64 v[90:91], v2 offset:904
    ds_read_b128 v[56:59], v1 offset:864
    v_mfma_f32_16x16x32_bf16 v[64:67], v[60:63], v[32:35], v[64:67]
    ds_read_b128 v[116:119], v1 offset:416
    v_mfma_f32_16x16x32_bf16 v[36:39], v[104:107], v[32:35], v[36:39]
    ds_read_b64 v[120:121], v2 offset:448
    s_waitcnt lgkmcnt(4)
    v_mfma_f32_16x16x32_bf16 v[36:39], v[112:115], v[108:111], v[36:39]
    ds_read_b64 v[122:123], v2 offset:456
    ds_read_b64 v[100:101], v2 offset:960
    s_waitcnt lgkmcnt(4)
    v_mfma_f32_16x16x32_bf16 v[52:55], v[88:91], v[108:111], v[52:55]
    ds_read_b64 v[102:103], v2 offset:968
    ds_read_b128 v[32:35], v1 offset:928
    v_mfma_f32_16x16x32_bf16 v[64:67], v[112:115], v[56:59], v[64:67]
    ds_read_b128 v[124:127], v1 offset:480
    v_mfma_f32_16x16x32_bf16 v[36:39], v[88:91], v[56:59], v[36:39]
    ds_read_b64 v[128:129], v2 offset:0
    s_waitcnt lgkmcnt(3)
    v_mfma_f32_16x16x32_bf16 v[52:55], v[100:103], v[116:119], v[52:55]
    ds_read_b128 v[108:111], v1 offset:992
    ds_read_b64 v[132:133], v2 offset:512
    v_mfma_f32_16x16x32_bf16 v[36:39], v[120:123], v[116:119], v[36:39]
    s_waitcnt lgkmcnt(4)
    v_mfma_f32_16x16x32_bf16 v[36:39], v[100:103], v[32:35], v[36:39]
    ds_read_b64 v[134:135], v2 offset:520
    ds_read_b64 v[130:131], v2 offset:8
    v_mfma_f32_16x16x32_bf16 v[64:67], v[120:123], v[32:35], v[64:67]
    s_setprio 0
    s_waitcnt lgkmcnt(0)
    v_mfma_f32_16x16x32_bf16 v[64:67], v[128:131], v[124:127], v[64:67]
    ds_read_b64 v[58:59], v2 offset:1032
    ds_read_b64 v[56:57], v2 offset:1024
    v_mfma_f32_16x16x32_bf16 v[36:39], v[132:135], v[124:127], v[36:39]
    ds_read_b64 v[118:119], v3 offset:120
    ds_read_b128 v[32:35], v1 offset:1120
    v_mfma_f32_16x16x32_bf16 v[136:139], v[68:71], v[124:127], 0
    s_waitcnt vmcnt(0)
    v_perm_b32 v0, v80, v76, s44
    s_waitcnt lgkmcnt(2)
    v_mfma_f32_16x16x32_bf16 v[52:55], v[56:59], v[124:127], v[52:55]
    ds_read_b128 v[140:143], v1 offset:1184
    ds_read_b128 v[144:147], v1 offset:1056
    v_perm_b32 v2, v81, v77, s44
    v_mfma_f32_16x16x32_bf16 v[36:39], v[56:59], v[108:111], v[36:39]
    v_perm_b32 v255, v83, v79, s44
    v_perm_b32 v254, v81, v77, s45
    v_perm_b32 v253, v82, v78, s45
    s_waitcnt lgkmcnt(2)
    v_mfma_f32_16x16x32_bf16 v[64:67], v[48:51], v[32:35], v[64:67]
    ds_write_addtid_b32 v0 offset:27136
    ds_read_b128 v[68:71], v1 offset:1248
    v_cvt_pk_bf16_f32 v250, v52, v53
    v_mfma_f32_16x16x32_bf16 v[64:67], v[132:135], v[108:111], v[64:67]
    v_cvt_pk_bf16_f32 v248, v36, v37
    v_cvt_pk_bf16_f32 v249, v38, v39
    v_mfma_f32_16x16x32_bf16 v[124:127], v[44:47], v[32:35], 0
    ds_write_b64 v5, v[248:249] offset:576
    ds_read_b128 v[148:151], v1 offset:1376
    s_waitcnt lgkmcnt(3)
    v_mfma_f32_16x16x32_bf16 v[64:67], v[28:31], v[144:147], v[64:67]
    v_perm_b32 v252, v82, v78, s44
    v_cvt_pk_bf16_f32 v251, v54, v55
    v_mfma_f32_16x16x32_bf16 v[124:127], v[72:75], v[140:143], v[124:127]
    ds_read_b128 v[32:35], v1 offset:1312
    ds_write_b64 v5, v[250:251] offset:0
    v_mfma_f32_16x16x32_bf16 v[124:127], v[128:131], v[108:111], v[124:127]
    v_perm_b32 v81, v80, v76, s45
    v_perm_b32 v82, v83, v79, s45
    v_mfma_f32_16x16x32_bf16 v[124:127], v[20:23], v[144:147], v[124:127]
    ds_read_b128 v[36:39], v1 offset:1440
    ds_read_b64 v[116:117], v3 offset:128
    ds_write_addtid_b32 v253 offset:50176
    s_setprio 3
    v_mfma_f32_16x16x32_bf16 v[64:67], v[84:87], v[140:143], v[64:67]
    s_waitcnt lgkmcnt(3)
    s_barrier
    ds_read_b64_tr_b16 v[52:53], v6 offset:576
    v_mfma_f32_16x16x32_bf16 v[124:127], v[92:95], v[68:71], v[124:127]
    ds_read_b64_tr_b16 v[54:55], v6 offset:29376
    ds_write_addtid_b32 v82 offset:59392
    v_mfma_f32_16x16x32_bf16 v[124:127], v[60:63], v[32:35], v[124:127]
    ds_read_b64_tr_b16 v[78:79], v6 offset:28800
    ds_write_addtid_b32 v255 offset:54784
    v_mfma_f32_16x16x32_bf16 v[64:67], v[104:107], v[32:35], v[64:67]
    ds_write_addtid_b32 v2 offset:36352
    v_mfma_f32_16x16x32_bf16 v[64:67], v[88:91], v[148:151], v[64:67]
    ds_read_b128 v[108:111], v1 offset:1504
    s_waitcnt lgkmcnt(5)
    buffer_store_dwordx4 v[52:55], v7, s[40:43], s5 offen
    ds_read_b64_tr_b16 v[76:77], v6 offset:0
    v_mfma_f32_16x16x32_bf16 v[64:67], v[96:99], v[116:119], v[64:67]
    ds_read_b64 v[34:35], v3 offset:104
    v_mfma_f32_16x16x32_bf16 v[64:67], v[40:43], v[68:71], v[64:67]
    ds_write_addtid_b32 v81 offset:31744
    ds_read_b64 v[32:33], v3 offset:112
    v_mfma_f32_16x16x32_bf16 v[124:127], v[112:115], v[148:151], v[124:127]
    ds_read_b64 v[52:53], v3 offset:256
    v_mfma_f32_16x16x32_bf16 v[124:127], v[120:123], v[36:39], v[124:127]
    ds_read_b128 v[140:143], v1 offset:976
    s_waitcnt lgkmcnt(5)
    v_mfma_f32_16x16x32_bf16 v[64:67], v[56:59], v[108:111], v[64:67]
    ds_read_b128 v[68:71], v1 offset:960
    buffer_store_dwordx4 v[76:79], v7, s[40:43], s4 offen
    s_waitcnt lgkmcnt(3)
    v_mfma_f32_16x16x32_bf16 v[64:67], v[24:27], v[32:35], v[64:67]
    ds_write_addtid_b32 v254 offset:40960
    ds_write_addtid_b32 v252 offset:45568
    v_mfma_f32_16x16x32_bf16 v[64:67], v[100:103], v[36:39], v[64:67]
    ds_read_b64 v[82:83], v3 offset:232
    s_setprio 1
    v_mfma_f32_16x16x32_bf16 v[124:127], v[132:135], v[108:111], v[124:127]
    ds_read_b128 v[76:79], v1 offset:1568
    s_waitcnt lgkmcnt(4)
    v_mfma_f32_16x16x32_bf16 v[144:147], v[140:143], v[12:15], 0
    ds_read_b128 v[148:151], v1 offset:1760
    ds_read_b128 v[36:39], v1 offset:1696
    v_mfma_f32_16x16x32_bf16 v[152:155], v[140:143], v[8:11], 0
    v_cvt_pk_bf16_f32 v254, v64, v65
    v_cvt_pk_bf16_f32 v255, v66, v67
    v_mfma_f32_16x16x32_bf16 v[156:159], v[68:71], v[8:11], 0
    ds_write_b64 v5, v[254:255] offset:1152
    v_mfma_f32_16x16x32_bf16 v[160:163], v[68:71], v[12:15], 0
    ds_read_b64 v[54:55], v3 offset:248
    s_waitcnt lgkmcnt(3)
    v_mfma_f32_16x16x32_bf16 v[136:139], v[20:23], v[76:79], v[136:139]
    ds_read_b64 v[80:81], v3 offset:240
    ds_read_b128 v[64:67], v1 offset:1632
    v_mfma_f32_16x16x32_bf16 v[136:139], v[128:131], v[108:111], v[136:139]
    s_waitcnt lgkmcnt(3)
    s_barrier
    v_mfma_f32_16x16x32_bf16 v[124:127], v[84:87], v[36:39], v[124:127]
    v_cvt_pk_bf16_f32 v70, v155, v147
    s_waitcnt lgkmcnt(0)
    v_mfma_f32_16x16x32_bf16 v[124:127], v[48:51], v[64:67], v[124:127]
    ds_read_b128 v[20:23], v1 offset:1888
    v_cvt_pk_bf16_f32 v143, v157, v161
    ds_read_b64_tr_b16 v[108:109], v6 offset:1152
    v_cvt_pk_bf16_f32 v71, v159, v163
    v_mfma_f32_16x16x32_bf16 v[124:127], v[96:99], v[52:55], v[124:127]
    ds_read_b128 v[128:131], v1 offset:2016
    v_cvt_pk_bf16_f32 v68, v154, v146
    v_mfma_f32_16x16x32_bf16 v[124:127], v[28:31], v[76:79], v[124:127]
    ds_read_b64_tr_b16 v[110:111], v6 offset:29952
    v_mfma_f32_16x16x32_bf16 v[136:139], v[44:47], v[64:67], v[136:139]
    ds_read_b128 v[164:167], v1 offset:1824
    v_cvt_pk_bf16_f32 v69, v158, v162
    s_waitcnt lgkmcnt(3)
    v_mfma_f32_16x16x32_bf16 v[124:127], v[88:91], v[20:23], v[124:127]
    s_waitcnt lgkmcnt(1)
    buffer_store_dwordx4 v[108:111], v7, s[40:43], s6 offen
    s_waitcnt lgkmcnt(0)
    v_mfma_f32_16x16x32_bf16 v[124:127], v[104:107], v[164:167], v[124:127]
    ds_read_b128 v[76:79], v1 offset:1472
    v_cvt_pk_bf16_f32 v140, v152, v144
    v_mfma_f32_16x16x32_bf16 v[124:127], v[56:59], v[128:131], v[124:127]
    ds_read_b128 v[44:47], v1 offset:1952
    v_mfma_f32_16x16x32_bf16 v[124:127], v[40:43], v[148:151], v[124:127]
    ds_read_b128 v[64:67], v1 offset:2208
    v_cvt_pk_bf16_f32 v142, v153, v145
    v_mfma_f32_16x16x32_bf16 v[124:127], v[24:27], v[80:83], v[124:127]
    ds_read_b128 v[108:111], v1 offset:1488
    v_cvt_pk_bf16_f32 v141, v156, v160
    v_mfma_f32_16x16x32_bf16 v[124:127], v[68:71], v[32:35], v[124:127]
    ds_read_b128 v[168:171], v1 offset:2464
    v_mfma_f32_16x16x32_bf16 v[124:127], v[140:143], v[116:119], v[124:127]
    ds_read_b64 v[146:147], v3 offset:376
    s_waitcnt lgkmcnt(3)
    v_mfma_f32_16x16x32_bf16 v[124:127], v[100:103], v[44:47], v[124:127]
    ds_read_b128 v[152:155], v1 offset:2272
    v_mfma_f32_16x16x32_bf16 v[136:139], v[112:115], v[20:23], v[136:139]
    ds_read_b64 v[144:145], v3 offset:384
    s_waitcnt lgkmcnt(4)
    v_mfma_f32_16x16x32_bf16 v[156:159], v[108:111], v[8:11], 0
    ds_read_b128 v[160:163], v1 offset:2080
    s_nop 1
    v_cvt_pk_bf16_f32 v254, v124, v125
    v_cvt_pk_bf16_f32 v255, v126, v127
    v_mfma_f32_16x16x32_bf16 v[172:175], v[108:111], v[12:15], 0
    ds_write_b64 v5, v[254:255] offset:1728
    v_mfma_f32_16x16x32_bf16 v[20:23], v[76:79], v[12:15], 0
    ds_read_b128 v[112:115], v1 offset:2144
    s_setprio 0
    v_mfma_f32_16x16x32_bf16 v[176:179], v[76:79], v[8:11], 0
    ds_read_b64 v[126:127], v3 offset:360
    v_mfma_f32_16x16x32_bf16 v[136:139], v[72:75], v[36:39], v[136:139]
    ds_read2_b32 v[108:109], v4 offset0:3 offset1:2
    v_mfma_f32_16x16x32_bf16 v[136:139], v[120:123], v[44:47], v[136:139]
    ds_read_b64 v[124:125], v3 offset:368
    s_waitcnt lgkmcnt(3)
    v_mfma_f32_16x16x32_bf16 v[136:139], v[48:51], v[112:115], v[136:139]
    s_barrier
    v_mfma_f32_16x16x32_bf16 v[136:139], v[84:87], v[64:67], v[136:139]
    ds_read_b64_tr_b16 v[10:11], v6 offset:30528
    v_cvt_pk_bf16_f32 v12, v158, v174
    v_mfma_f32_16x16x32_bf16 v[136:139], v[40:43], v[152:155], v[136:139]
    ds_read_b64_tr_b16 v[8:9], v6 offset:1728
    s_waitcnt lgkmcnt(2)
    v_mfma_f32_16x16x32_bf16 v[136:139], v[24:27], v[124:127], v[136:139]
    ds_read_b128 v[36:39], v1 offset:2336
    v_mfma_f32_16x16x32_bf16 v[136:139], v[96:99], v[144:147], v[136:139]
    ds_read_b128 v[44:47], v1 offset:2400
    ds_read2_b32 v[110:111], v4 offset0:1 offset1:0
    s_waitcnt lgkmcnt(3)
    buffer_store_dwordx4 v[8:11], v7, s[40:43], s7 offen
    s_waitcnt lgkmcnt(0)
    v_mfma_f32_16x16x32_bf16 v[136:139], v[16:19], v[108:111], v[136:139]
    v_mfma_f32_16x16x32_bf16 v[136:139], v[140:143], v[52:55], v[136:139]
    v_mfma_f32_16x16x32_bf16 v[136:139], v[60:63], v[164:167], v[136:139]
    v_cvt_pk_bf16_f32 v15, v179, v23
    v_cvt_pk_bf16_f32 v14, v159, v175
    v_mfma_f32_16x16x32_bf16 v[136:139], v[100:103], v[168:171], v[136:139]
    v_cvt_pk_bf16_f32 v13, v178, v22
    v_cvt_pk_bf16_f32 v10, v157, v173
    v_mfma_f32_16x16x32_bf16 v[136:139], v[92:95], v[148:151], v[136:139]
    v_cvt_pk_bf16_f32 v11, v177, v21
    v_mfma_f32_16x16x32_bf16 v[136:139], v[132:135], v[128:131], v[136:139]
    ds_read_b128 v[16:19], v1 offset:2528
    v_mfma_f32_16x16x32_bf16 v[136:139], v[12:15], v[32:35], v[136:139]
    v_cvt_pk_bf16_f32 v9, v176, v20
    v_cvt_pk_bf16_f32 v8, v156, v172
    v_mfma_f32_16x16x32_bf16 v[136:139], v[104:107], v[36:39], v[136:139]
    s_nop 0
    v_mfma_f32_16x16x32_bf16 v[136:139], v[8:11], v[116:119], v[136:139]
    v_mfma_f32_16x16x32_bf16 v[136:139], v[88:91], v[44:47], v[136:139]
    v_mfma_f32_16x16x32_bf16 v[136:139], v[68:71], v[80:83], v[136:139]
    s_waitcnt lgkmcnt(0)
    v_mfma_f32_16x16x32_bf16 v[136:139], v[56:59], v[16:19], v[136:139]
    v_mfma_f32_16x16x32_bf16 v[136:139], v[28:31], v[160:163], v[136:139]
    s_nop 7
    v_cvt_pk_bf16_f32 v255, v138, v139
    v_cvt_pk_bf16_f32 v254, v136, v137
    ds_write_b64 v5, v[254:255] offset:2304
    s_waitcnt lgkmcnt(0)
    s_barrier
    ds_read_b64_tr_b16 v[0:1], v6 offset:2304
    ds_read_b64_tr_b16 v[2:3], v6 offset:31104
    s_waitcnt lgkmcnt(0)
    buffer_store_dwordx4 v[0:3], v7, s[40:43], s8 offen
    s_endpgm
Lend:
    s_endpgm
.section .rodata,"a"
.p2align 6
.amdhsa_kernel standalone__ssm_conv_s4__prompt_kernel
  .amdhsa_next_free_vgpr 256
  .amdhsa_next_free_sgpr 102
  .amdhsa_accum_offset 256
  .amdhsa_group_segment_fixed_size 0
  .amdhsa_kernarg_size 96
  .amdhsa_user_sgpr_count 2
  .amdhsa_user_sgpr_kernarg_segment_ptr 1
  .amdhsa_system_sgpr_workgroup_id_x 1
.end_amdhsa_kernel
```
